```python
import torch

def _softmax(x, axis=-1):
    return torch.softmax(x, dim=axis)

def _gelu(x):
    return torch.nn.functional.gelu(x, approximate='tanh')

def _silu(x):
    return torch.nn.functional.silu(x)

def _sigmoid(x):
    return torch.sigmoid(x)

def _layernorm(x, axis=-1, eps=1e-05):
    m = x.mean(dim=axis, keepdim=True)
    v = x.var(dim=axis, keepdim=True, unbiased=False)
    return (x - m) / torch.sqrt(v + eps)

def _scatter_add(tgt, idx, src, axis=0):
    return tgt.clone().index_add_(axis, idx, src)

def _segment_sum(src, seg, n):
    out = torch.zeros((n,) + src.shape[1:], dtype=src.dtype)
    return out.index_add_(0, seg, src)

def _pad(x, pw):
    flat = tuple((v for pair in reversed(pw) for v in pair))
    return torch.nn.functional.pad(x, flat)
kernel_name = 'standalone__kv_cache_quant_pre_rope_vs_post_rope__prompt'

def setup_inputs():

    _w = lambda a: (lambda t: t.to(torch.bfloat16) if t.is_floating_point() else t)(torch.as_tensor(a))
    B, Sq, Skv = (1, 2048, 2048)
    H, Dh0 = (8, 128)
    G = 32 if 32 > 0 else Dh0
    G = max(2, G // 2 * 2)
    Dh = max(G, Dh0 // G * G)
    Skv = max(Skv, Sq)
    ng = Dh // G
    bits = 8 if 8 > 1 else 4
    bits = max(2, min(8, bits))
    qmax = (1 << bits) - 1
    half = Dh // 2
    inv = 1.0 / 10000.0 ** (torch.arange(half) / max(1, half))
    ang_k = torch.arange(Skv)[:, None] * inv[None, :]
    ang_q = torch.arange(Skv - Sq, Skv)[:, None] * inv[None, :]
    kc = torch.cat([torch.cos(ang_k), torch.cos(ang_k)], dim=-1)
    ks = torch.cat([torch.sin(ang_k), torch.sin(ang_k)], dim=-1)
    qc = torch.cat([torch.cos(ang_q), torch.cos(ang_q)], dim=-1)
    qs = torch.cat([torch.sin(ang_q), torch.sin(ang_q)], dim=-1)
    qk_i = torch.randint(0, qmax + 1, (B, H, Skv, Dh)).to(torch.int32)
    qv_i = torch.randint(0, qmax + 1, (B, H, Skv, Dh)).to(torch.int32)
    ksc = torch.abs((lambda *s: torch.randn(*s, dtype=torch.bfloat16) * 0.05)(B, H, Skv, ng)) * 0.1 + 0.01
    kzp = torch.full((B, H, Skv, ng), qmax / 2.0)
    vsc = torch.abs((lambda *s: torch.randn(*s, dtype=torch.bfloat16) * 0.05)(B, H, Skv, ng)) * 0.1 + 0.01
    vzp = torch.full((B, H, Skv, ng), qmax / 2.0)
    return {'q': _w((lambda *s: torch.randn(*s, dtype=torch.bfloat16) * 0.8)(B, H, Sq, Dh) * 0.5), 'qk': _w(qk_i), 'k_scales': _w(ksc), 'k_zeros': _w(kzp), 'qv': _w(qv_i), 'v_scales': _w(vsc), 'v_zeros': _w(vzp), 'q_cos': _w(qc), 'q_sin': _w(qs), 'k_cos': _w(kc), 'k_sin': _w(ks)}

def reference(q, qk, k_scales, k_zeros, qv, v_scales, v_zeros, q_cos, q_sin, k_cos, k_sin):
    B, H, Sq, Dh = q.shape
    ng = k_scales.shape[-1]
    G = Dh // ng
    half = Dh // 2
    ks = (lambda x, n, axis: torch.repeat_interleave(x, n, dim=axis))(k_scales, G, axis=-1)
    kz = (lambda x, n, axis: torch.repeat_interleave(x, n, dim=axis))(k_zeros, G, axis=-1)
    k = ((lambda x, dt: x.to(dt))(qk, q.dtype) - kz) * ks
    vs = (lambda x, n, axis: torch.repeat_interleave(x, n, dim=axis))(v_scales, G, axis=-1)
    vz = (lambda x, n, axis: torch.repeat_interleave(x, n, dim=axis))(v_zeros, G, axis=-1)
    v = ((lambda x, dt: x.to(dt))(qv, q.dtype) - vz) * vs
    k1 = k[..., :half].clone()
    k2 = k[..., half:].clone()
    krh = torch.concatenate([-k2, k1], axis=-1)
    kr = k * k_cos[None, None, :, :] + krh * k_sin[None, None, :, :]
    q1 = q[..., :half].clone()
    q2 = q[..., half:].clone()
    qrh = torch.concatenate([-q2, q1], axis=-1)
    qr = q * q_cos[None, None, :, :] + qrh * q_sin[None, None, :, :]
    logits = torch.einsum('bhqd,bhkd->bhqk', qr, kr) * float(Dh) ** (-0.5)
    attn = _softmax(logits, axis=-1)
    out = torch.einsum('bhqk,bhkd->bhqd', attn, v)
    return out
```

```asm
; @launch grid=(256,1,1) block=(256,1,1) lds=86048
.amdgcn_target "amdgcn-amd-amdhsa--gfx950"
.text
.globl standalone__kv_cache_quant_pre_rope_vs_post_rope__prompt_kernel
.p2align 8
.type standalone__kv_cache_quant_pre_rope_vs_post_rope__prompt_kernel,@function
standalone__kv_cache_quant_pre_rope_vs_post_rope__prompt_kernel:
  s_cmp_ge_u32 s2, 256
  s_cbranch_scc1 M_end
  s_load_dwordx16 s[8:23], s[0:1], 0
  s_load_dwordx8 s[24:31], s[0:1], 64
  s_load_dwordx4 s[32:35], s[0:1], 96
  s_getpc_b64 s[56:57]
  v_lshlrev_b32 v1, 6, v0
  v_min_u32 v1, M_codeend-standalone__kv_cache_quant_pre_rope_vs_post_rope__prompt_kernel-64, v1
  global_load_dword v6, v1, s[56:57]
  v_lshrrev_b32 v1, 6, v0
  v_and_b32 v2, 63, v0
  v_readfirstlane_b32 s3, v1
  v_and_b32 v3, 15, v2
  v_lshrrev_b32 v4, 4, v2
  s_and_b32 s38, s2, 7
  s_lshr_b32 s39, s2, 3
  s_xor_b32 s37, s3, 2
  s_lshl_b32 s56, s39, 6
  s_lshl_b32 s57, s37, 3
  s_add_u32 s61, s56, s57
  s_lshl_b32 s57, s3, 3
  s_add_u32 s56, s56, s57
  s_lshl_b32 s57, s38, 11
  s_add_u32 s56, s56, s57
  s_add_u32 s57, s57, s61
  s_lshl_b32 s58, s56, 9
  v_lshl_add_u32 v12, v2, 3, s58
  v_add_u32 v13, 16384, v12
  v_lshlrev_b32 v0, 8, v4
  v_lshl_add_u32 v0, v3, 3, v0
  s_lshl_b32 s58, s57, 8
  v_add_u32 v20, s58, v0
  v_add_u32 v21, 8192, v20
  v_lshlrev_b32 v14, 1, v20
  v_lshlrev_b32 v15, 1, v21
  s_lshl_b32 s58, s56, 3
  v_lshrrev_b32 v0, 3, v3
  v_lshl_add_u32 v18, v0, 8, s58
  v_and_b32 v1, 7, v3
  v_lshl_add_u32 v18, v1, 3, v18
  v_lshl_add_u32 v18, v4, 1, v18
  s_lshl_b32 s58, s57, 3
  v_lshl_add_u32 v19, v0, 1, s58
  v_lshl_add_u32 v19, v4, 3, v19
  v_bfe_u32 v1, v3, 2, 1
  v_lshl_add_u32 v19, v1, 8, v19
  v_bfe_u32 v1, v3, 1, 1
  v_lshl_add_u32 v19, v1, 5, v19
  v_and_b32 v1, 1, v3
  v_lshl_add_u32 v19, v1, 2, v19
  v_mov_b32 v188, 0
  v_mov_b32 v189, 0
  v_mov_b32 v190, 0
  v_mov_b32 v191, 0
  s_waitcnt lgkmcnt(0)
  global_load_short_d16_hi v188, v18, s[18:19]
  global_load_short_d16_hi v189, v18, s[20:21]
  global_load_short_d16_hi v190, v19, s[12:13]
  global_load_short_d16_hi v191, v19, s[14:15]
  s_cmp_lt_u32 s3, 2
  s_cbranch_scc0 M_ld1_b
  global_load_dwordx2 v[52:53], v12, s[16:17] offset:0
  global_load_dwordx2 v[54:55], v12, s[16:17] offset:512
  global_load_dwordx2 v[56:57], v12, s[16:17] offset:1024
  global_load_dwordx2 v[58:59], v12, s[16:17] offset:1536
  global_load_dwordx2 v[60:61], v12, s[16:17] offset:2048
  global_load_dwordx2 v[62:63], v12, s[16:17] offset:2560
  global_load_dwordx2 v[64:65], v12, s[16:17] offset:3072
  global_load_dwordx2 v[66:67], v12, s[16:17] offset:3584
  s_branch M_ld1_e
M_ld1_b:
  global_load_dwordx4 v[76:79], v14, s[10:11] offset:0
  global_load_dwordx4 v[80:83], v14, s[10:11] offset:256
  global_load_dwordx4 v[84:87], v14, s[10:11] offset:2048
  global_load_dwordx4 v[88:91], v14, s[10:11] offset:2304
M_ld1_e:
  v_mov_b32 v242, 86016
  v_mov_b32 v243, 1
  v_mov_b32 v28, 0
  v_mov_b32 v29, 0
  v_mov_b32 v30, 0
  v_mov_b32 v31, 0
  ds_write_b128 v242, v[28:31]
  v_lshlrev_b32 v0, 2, v3
  v_cvt_f32_u32 v0, v0
  s_mov_b32 s59, 0xbe549a78
  v_mul_f32 v108, s59, v0
  v_add_f32 v1, 1.0, v0
  v_mul_f32 v109, s59, v1
  v_add_f32 v1, 2.0, v0
  v_mul_f32 v110, s59, v1
  v_add_f32 v1, 0x40400000, v0
  v_mul_f32 v111, s59, v1
  v_exp_f32 v108, v108
  v_exp_f32 v109, v109
  v_exp_f32 v110, v110
  v_exp_f32 v111, v111
  v_add_u32 v0, s61, v4
  v_add_u32 v1, 0, v0
  v_cvt_f32_u32 v1, v1
  v_mul_f32 v156, v1, v108
  v_mul_f32 v157, v1, v109
  v_mul_f32 v158, v1, v110
  v_mul_f32 v159, v1, v111
  v_mul_f32 v156, 0.15915494, v156
  v_mul_f32 v157, 0.15915494, v157
  s_cmp_lt_u32 s3, 2
  s_cbranch_scc0 M_ld2_b
  global_load_dwordx4 v[76:79], v14, s[10:11] offset:0
  global_load_dwordx4 v[80:83], v14, s[10:11] offset:256
  global_load_dwordx4 v[84:87], v14, s[10:11] offset:2048
  global_load_dwordx4 v[88:91], v14, s[10:11] offset:2304
  s_branch M_ld2_e
M_ld2_b:
  global_load_dwordx2 v[52:53], v12, s[16:17] offset:0
  global_load_dwordx2 v[54:55], v12, s[16:17] offset:512
  global_load_dwordx2 v[56:57], v12, s[16:17] offset:1024
  global_load_dwordx2 v[58:59], v12, s[16:17] offset:1536
  global_load_dwordx2 v[60:61], v12, s[16:17] offset:2048
  global_load_dwordx2 v[62:63], v12, s[16:17] offset:2560
  global_load_dwordx2 v[64:65], v12, s[16:17] offset:3072
  global_load_dwordx2 v[66:67], v12, s[16:17] offset:3584
M_ld2_e:
  v_mul_f32 v158, 0.15915494, v158
  v_mul_f32 v159, 0.15915494, v159
  v_fract_f32 v156, v156
  v_fract_f32 v157, v157
  v_fract_f32 v158, v158
  v_fract_f32 v159, v159
  v_sin_f32 v160, v156
  v_sin_f32 v161, v157
  v_sin_f32 v162, v158
  v_sin_f32 v163, v159
  v_cos_f32 v156, v156
  v_cos_f32 v157, v157
  v_cos_f32 v158, v158
  v_cos_f32 v159, v159
  v_cvt_pk_bf16_f32 v34, v160, v161
  v_cvt_pk_bf16_f32 v35, v162, v163
  v_cvt_pk_bf16_f32 v32, v156, v157
  v_cvt_pk_bf16_f32 v33, v158, v159
  v_lshlrev_b32 v156, 16, v32
  v_and_b32 v157, 0xffff0000, v32
  v_lshlrev_b32 v158, 16, v33
  v_and_b32 v159, 0xffff0000, v33
  v_lshlrev_b32 v160, 16, v34
  v_and_b32 v161, 0xffff0000, v34
  v_lshlrev_b32 v162, 16, v35
  v_and_b32 v163, 0xffff0000, v35
  v_add_u32 v1, 4, v0
  v_cvt_f32_u32 v1, v1
  v_mul_f32 v164, v1, v108
  v_mul_f32 v165, v1, v109
  v_mul_f32 v166, v1, v110
  v_mul_f32 v167, v1, v111
  v_mul_f32 v164, 0.15915494, v164
  v_mul_f32 v165, 0.15915494, v165
  v_mul_f32 v166, 0.15915494, v166
  v_mul_f32 v167, 0.15915494, v167
  v_fract_f32 v164, v164
  v_fract_f32 v165, v165
  v_fract_f32 v166, v166
  v_fract_f32 v167, v167
  v_sin_f32 v168, v164
  v_sin_f32 v169, v165
  v_sin_f32 v170, v166
  v_sin_f32 v171, v167
  v_cos_f32 v164, v164
  v_cos_f32 v165, v165
  v_cos_f32 v166, v166
  v_cos_f32 v167, v167
  v_cvt_pk_bf16_f32 v34, v168, v169
  v_cvt_pk_bf16_f32 v35, v170, v171
  global_load_dwordx2 v[140:141], v20, s[8:9] offset:0
  global_load_dwordx2 v[142:143], v20, s[8:9] offset:128
  global_load_dwordx2 v[144:145], v20, s[8:9] offset:1024
  global_load_dwordx2 v[146:147], v20, s[8:9] offset:1152
  global_load_dwordx2 v[148:149], v21, s[8:9] offset:0
  global_load_dwordx2 v[150:151], v21, s[8:9] offset:128
  global_load_dwordx2 v[152:153], v21, s[8:9] offset:1024
  global_load_dwordx2 v[154:155], v21, s[8:9] offset:1152
  v_cvt_pk_bf16_f32 v32, v164, v165
  v_cvt_pk_bf16_f32 v33, v166, v167
  v_lshlrev_b32 v164, 16, v32
  v_and_b32 v165, 0xffff0000, v32
  v_lshlrev_b32 v166, 16, v33
  v_and_b32 v167, 0xffff0000, v33
  v_lshlrev_b32 v168, 16, v34
  v_and_b32 v169, 0xffff0000, v34
  v_lshlrev_b32 v170, 16, v35
  v_and_b32 v171, 0xffff0000, v35
  s_lshr_b32 s56, s39, 3
  s_lshl_b32 s56, s56, 18
  s_lshl_b32 s57, s38, 20
  s_add_u32 s56, s56, s57
  s_bfe_u32 s57, s39, 0x20001
  s_lshl_b32 s57, s57, 14
  s_add_u32 s56, s56, s57
  s_and_b32 s57, s39, 1
  s_lshl_b32 s57, s57, 9
  s_add_u32 s56, s56, s57
  s_and_b32 s57, s3, 1
  s_lshl_b32 s57, s57, 8
  s_add_u32 s56, s56, s57
  s_lshr_b32 s57, s37, 1
  s_lshl_b32 s57, s57, 16
  s_lshr_b32 s58, s3, 1
  s_lshl_b32 s58, s58, 16
  s_add_u32 s57, s57, s56
  s_add_u32 s57, s57, 4096
  s_add_u32 s58, s58, s56
  s_add_u32 s58, s58, 8192
  v_lshrrev_b32 v0, 2, v3
  v_lshl_add_u32 v22, v0, 10, s57
  v_and_b32 v0, 3, v3
  v_lshl_add_u32 v22, v0, 6, v22
  v_lshl_add_u32 v22, v4, 4, v22
  v_lshrrev_b32 v0, 5, v2
  v_lshl_add_u32 v23, v0, 12, s58
  v_and_b32 v0, 1, v2
  v_lshl_add_u32 v23, v0, 11, v23
  v_bfe_u32 v0, v2, 1, 4
  v_lshl_add_u32 v23, v0, 4, v23
  s_lshl_b32 s58, s3, 6
  s_add_u32 s58, s58, 81920
  v_lshl_add_u32 v25, v3, 8, s58
  v_lshl_add_u32 v25, v4, 4, v25
  s_lshl_b32 s58, s38, 5
  s_add_u32 s58, s58, s39
  s_lshl_b32 s58, s58, 14
  s_lshl_b32 s59, s3, 12
  s_add_u32 s58, s58, s59
  s_add_u32 s44, s30, s58
  s_addc_u32 s45, s31, 0
  s_mov_b32 s46, 0x1000
  s_mov_b32 s47, 0x20000
  v_lshrrev_b32 v0, 2, v3
  v_lshlrev_b32 v0, 8, v0
  v_lshl_add_u32 v0, v4, 6, v0
  v_and_b32 v1, 3, v3
  v_lshl_add_u32 v8, v1, 4, v0
  v_add_u32 v9, 4096, v8
  v_lshlrev_b32 v7, 4, v2
  v_mov_b32 v0, 0x3f803f80
  v_add_u32 v10, 8192, v7
  v_add_u32 v11, 12288, v7
  v_accvgpr_write_b32 a192, v0
  v_accvgpr_write_b32 a193, v0
  v_accvgpr_write_b32 a194, v0
  v_accvgpr_write_b32 a195, v0
  v_lshrrev_b32 v0, 2, v3
  v_cmp_eq_u32 vcc, v0, v4
  v_lshlrev_b32 v1, 4, v1
  v_mov_b32 v0, 0x3f80
  v_cndmask_b32 v28, 0, v0, vcc
  v_mov_b32 v29, 0
  v_lshlrev_b64 v[28:29], v1, v[28:29]
  v_accvgpr_write_b32 a196, 0
  v_accvgpr_write_b32 a197, 0
  v_accvgpr_write_b32 a200, 0
  v_accvgpr_write_b32 a201, 0
  v_accvgpr_write_b32 a198, v28
  v_accvgpr_write_b32 a199, v29
  s_lshl_b32 s58, s38, 20
  s_lshl_b32 s59, s3, 18
  s_add_u32 s58, s58, s59
  s_add_u32 s40, s34, s58
  s_addc_u32 s41, s35, 0
  s_mov_b32 s42, 0x40000
  s_mov_b32 s43, 0x20000
  s_mov_b32 s50, 0
  s_mov_b32 s55, 0
  s_mov_b32 s4, 0
  s_mov_b32 s5, 0
  s_mov_b32 s52, 0
  s_and_b32 s53, s39, 0
  s_lshl_b32 s53, s53, 14
  s_mov_b32 s48, s53
  s_lshl_b32 s59, s3, 12
  s_add_u32 s59, s59, 65536
  v_add_u32 v237, s59, v7
  v_xor_b32 v234, 0x1000, v237
  v_xor_b32 v235, 0x2000, v237
  v_xor_b32 v236, 0x3000, v237
  v_and_b32 v238, 0x330, v7
  v_add_u32 v238, 81920, v238
  s_lshl_b32 s58, s3, 14
  v_add_u32 v241, s58, v7
  v_xor_b32 v252, 0x4000, v241
  v_xor_b32 v253, 0x8000, v241
  v_xor_b32 v254, 0xc000, v241
  v_lshlrev_b32 v240, 10, v4
  v_lshl_add_u32 v240, v3, 3, v240
  s_waitcnt lgkmcnt(0)
  s_barrier
  s_waitcnt vmcnt(20)
  v_mul_f32 v190, 0x3e0293ee, v190
  v_mul_f32 v191, v191, v190
  ds_swizzle_b32 v192, v190 offset:swizzle(BROADCAST,8,0)
  ds_swizzle_b32 v193, v191 offset:swizzle(BROADCAST,8,0)
  ds_swizzle_b32 v194, v190 offset:swizzle(BROADCAST,8,1)
  ds_swizzle_b32 v195, v191 offset:swizzle(BROADCAST,8,1)
  ds_swizzle_b32 v196, v190 offset:swizzle(BROADCAST,8,2)
  ds_swizzle_b32 v197, v191 offset:swizzle(BROADCAST,8,2)
  ds_swizzle_b32 v198, v190 offset:swizzle(BROADCAST,8,3)
  ds_swizzle_b32 v199, v191 offset:swizzle(BROADCAST,8,3)
  ds_swizzle_b32 v200, v190 offset:swizzle(BROADCAST,8,4)
  ds_swizzle_b32 v201, v191 offset:swizzle(BROADCAST,8,4)
  ds_swizzle_b32 v202, v190 offset:swizzle(BROADCAST,8,5)
  ds_swizzle_b32 v203, v191 offset:swizzle(BROADCAST,8,5)
  ds_swizzle_b32 v204, v190 offset:swizzle(BROADCAST,8,6)
  ds_swizzle_b32 v205, v191 offset:swizzle(BROADCAST,8,6)
  ds_swizzle_b32 v206, v190 offset:swizzle(BROADCAST,8,7)
  ds_swizzle_b32 v207, v191 offset:swizzle(BROADCAST,8,7)
  s_cmp_lt_u32 s3, 2
  s_cbranch_scc0 M_h0b
  s_waitcnt vmcnt(18)
  v_cvt_f32_i32 v52, v52
  v_cvt_f32_i32 v53, v53
  v_cvt_f32_i32 v54, v54
  v_cvt_f32_i32 v55, v55
  v_subrev_f32_dpp v52, v189, v52 row_newbcast:0 row_mask:0xf bank_mask:0xf
  v_subrev_f32_dpp v53, v189, v53 row_newbcast:0 row_mask:0xf bank_mask:0xf
  v_subrev_f32_dpp v54, v189, v54 row_newbcast:1 row_mask:0xf bank_mask:0xf
  v_subrev_f32_dpp v55, v189, v55 row_newbcast:1 row_mask:0xf bank_mask:0xf
  v_mul_f32_dpp v52, v188, v52 row_newbcast:0 row_mask:0xf bank_mask:0xf
  v_mul_f32_dpp v53, v188, v53 row_newbcast:0 row_mask:0xf bank_mask:0xf
  v_mul_f32_dpp v54, v188, v54 row_newbcast:1 row_mask:0xf bank_mask:0xf
  v_mul_f32_dpp v55, v188, v55 row_newbcast:1 row_mask:0xf bank_mask:0xf
  v_cvt_pk_bf16_f32 v68, v52, v54
  v_cvt_pk_bf16_f32 v72, v53, v55
  s_waitcnt vmcnt(16)
  v_cvt_f32_i32 v56, v56
  v_cvt_f32_i32 v57, v57
  v_cvt_f32_i32 v58, v58
  v_cvt_f32_i32 v59, v59
  v_subrev_f32_dpp v56, v189, v56 row_newbcast:2 row_mask:0xf bank_mask:0xf
  v_subrev_f32_dpp v57, v189, v57 row_newbcast:2 row_mask:0xf bank_mask:0xf
  v_subrev_f32_dpp v58, v189, v58 row_newbcast:3 row_mask:0xf bank_mask:0xf
  v_subrev_f32_dpp v59, v189, v59 row_newbcast:3 row_mask:0xf bank_mask:0xf
  v_mul_f32_dpp v56, v188, v56 row_newbcast:2 row_mask:0xf bank_mask:0xf
  v_mul_f32_dpp v57, v188, v57 row_newbcast:2 row_mask:0xf bank_mask:0xf
  v_mul_f32_dpp v58, v188, v58 row_newbcast:3 row_mask:0xf bank_mask:0xf
  v_mul_f32_dpp v59, v188, v59 row_newbcast:3 row_mask:0xf bank_mask:0xf
  v_cvt_pk_bf16_f32 v69, v56, v58
  v_cvt_pk_bf16_f32 v73, v57, v59
  s_waitcnt vmcnt(14)
  v_cvt_f32_i32 v60, v60
  v_cvt_f32_i32 v61, v61
  v_cvt_f32_i32 v62, v62
  v_cvt_f32_i32 v63, v63
  v_subrev_f32_dpp v60, v189, v60 row_newbcast:4 row_mask:0xf bank_mask:0xf
  v_subrev_f32_dpp v61, v189, v61 row_newbcast:4 row_mask:0xf bank_mask:0xf
  v_subrev_f32_dpp v62, v189, v62 row_newbcast:5 row_mask:0xf bank_mask:0xf
  v_subrev_f32_dpp v63, v189, v63 row_newbcast:5 row_mask:0xf bank_mask:0xf
  v_mul_f32_dpp v60, v188, v60 row_newbcast:4 row_mask:0xf bank_mask:0xf
  v_mul_f32_dpp v61, v188, v61 row_newbcast:4 row_mask:0xf bank_mask:0xf
  v_mul_f32_dpp v62, v188, v62 row_newbcast:5 row_mask:0xf bank_mask:0xf
  v_mul_f32_dpp v63, v188, v63 row_newbcast:5 row_mask:0xf bank_mask:0xf
  v_cvt_pk_bf16_f32 v70, v60, v62
  v_cvt_pk_bf16_f32 v74, v61, v63
  s_waitcnt vmcnt(12)
  v_cvt_f32_i32 v64, v64
  v_cvt_f32_i32 v65, v65
  v_cvt_f32_i32 v66, v66
  v_cvt_f32_i32 v67, v67
  v_subrev_f32_dpp v64, v189, v64 row_newbcast:6 row_mask:0xf bank_mask:0xf
  v_subrev_f32_dpp v65, v189, v65 row_newbcast:6 row_mask:0xf bank_mask:0xf
  v_subrev_f32_dpp v66, v189, v66 row_newbcast:7 row_mask:0xf bank_mask:0xf
  v_subrev_f32_dpp v67, v189, v67 row_newbcast:7 row_mask:0xf bank_mask:0xf
  v_mul_f32_dpp v64, v188, v64 row_newbcast:6 row_mask:0xf bank_mask:0xf
  v_mul_f32_dpp v65, v188, v65 row_newbcast:6 row_mask:0xf bank_mask:0xf
  v_mul_f32_dpp v66, v188, v66 row_newbcast:7 row_mask:0xf bank_mask:0xf
  v_mul_f32_dpp v67, v188, v67 row_newbcast:7 row_mask:0xf bank_mask:0xf
  v_cvt_pk_bf16_f32 v71, v64, v66
  v_cvt_pk_bf16_f32 v75, v65, v67
  global_store_dwordx4 v23, v[68:71], s[34:35] offset:0 sc0 sc1
  global_store_dwordx4 v23, v[72:75], s[34:35] offset:1024 sc0 sc1
  s_branch M_h0e
M_h0b:
  s_waitcnt vmcnt(18)
  s_waitcnt lgkmcnt(0)
  v_cvt_f32_i32 v76, v76
  v_cvt_f32_i32 v77, v77
  v_cvt_f32_i32 v78, v78
  v_cvt_f32_i32 v79, v79
  v_cvt_f32_i32 v80, v80
  v_cvt_f32_i32 v81, v81
  v_cvt_f32_i32 v82, v82
  v_cvt_f32_i32 v83, v83
  v_pk_fma_f32 v[76:77], v[76:77], v[192:193], v[192:193] op_sel:[0,0,1] op_sel_hi:[1,0,1] neg_lo:[0,0,1] neg_hi:[0,0,1]
  v_pk_fma_f32 v[78:79], v[78:79], v[192:193], v[192:193] op_sel:[0,0,1] op_sel_hi:[1,0,1] neg_lo:[0,0,1] neg_hi:[0,0,1]
  v_pk_fma_f32 v[80:81], v[80:81], v[194:195], v[194:195] op_sel:[0,0,1] op_sel_hi:[1,0,1] neg_lo:[0,0,1] neg_hi:[0,0,1]
  v_pk_fma_f32 v[82:83], v[82:83], v[194:195], v[194:195] op_sel:[0,0,1] op_sel_hi:[1,0,1] neg_lo:[0,0,1] neg_hi:[0,0,1]
  v_pk_mul_f32 v[28:29], v[76:77], v[156:157]
  v_pk_mul_f32 v[32:33], v[80:81], v[156:157]
  v_pk_mul_f32 v[30:31], v[78:79], v[158:159]
  v_pk_mul_f32 v[34:35], v[82:83], v[158:159]
  v_pk_fma_f32 v[28:29], v[80:81], v[160:161], v[28:29] neg_lo:[1,0,0] neg_hi:[1,0,0]
  v_pk_fma_f32 v[32:33], v[76:77], v[160:161], v[32:33]
  v_pk_fma_f32 v[30:31], v[82:83], v[162:163], v[30:31] neg_lo:[1,0,0] neg_hi:[1,0,0]
  v_pk_fma_f32 v[34:35], v[78:79], v[162:163], v[34:35]
  v_cvt_pk_bf16_f32 v76, v28, v29
  v_cvt_pk_bf16_f32 v77, v30, v31
  v_cvt_pk_bf16_f32 v78, v32, v33
  v_cvt_pk_bf16_f32 v79, v34, v35
  global_store_dwordx4 v22, v[76:79], s[34:35] offset:-4096 sc0 sc1
  ds_write_b128 v25, v[76:79]
  s_waitcnt vmcnt(17)
  v_cvt_f32_i32 v84, v84
  v_cvt_f32_i32 v85, v85
  v_cvt_f32_i32 v86, v86
  v_cvt_f32_i32 v87, v87
  v_cvt_f32_i32 v88, v88
  v_cvt_f32_i32 v89, v89
  v_cvt_f32_i32 v90, v90
  v_cvt_f32_i32 v91, v91
  v_pk_fma_f32 v[84:85], v[84:85], v[196:197], v[196:197] op_sel:[0,0,1] op_sel_hi:[1,0,1] neg_lo:[0,0,1] neg_hi:[0,0,1]
  v_pk_fma_f32 v[86:87], v[86:87], v[196:197], v[196:197] op_sel:[0,0,1] op_sel_hi:[1,0,1] neg_lo:[0,0,1] neg_hi:[0,0,1]
  v_pk_fma_f32 v[88:89], v[88:89], v[198:199], v[198:199] op_sel:[0,0,1] op_sel_hi:[1,0,1] neg_lo:[0,0,1] neg_hi:[0,0,1]
  v_pk_fma_f32 v[90:91], v[90:91], v[198:199], v[198:199] op_sel:[0,0,1] op_sel_hi:[1,0,1] neg_lo:[0,0,1] neg_hi:[0,0,1]
  v_pk_mul_f32 v[28:29], v[84:85], v[164:165]
  v_pk_mul_f32 v[32:33], v[88:89], v[164:165]
  v_pk_mul_f32 v[30:31], v[86:87], v[166:167]
  v_pk_mul_f32 v[34:35], v[90:91], v[166:167]
  v_pk_fma_f32 v[28:29], v[88:89], v[168:169], v[28:29] neg_lo:[1,0,0] neg_hi:[1,0,0]
  v_pk_fma_f32 v[32:33], v[84:85], v[168:169], v[32:33]
  v_pk_fma_f32 v[30:31], v[90:91], v[170:171], v[30:31] neg_lo:[1,0,0] neg_hi:[1,0,0]
  v_pk_fma_f32 v[34:35], v[86:87], v[170:171], v[34:35]
  v_cvt_pk_bf16_f32 v84, v28, v29
  v_cvt_pk_bf16_f32 v85, v30, v31
  v_cvt_pk_bf16_f32 v86, v32, v33
  v_cvt_pk_bf16_f32 v87, v34, v35
  global_store_dwordx4 v22, v[84:87], s[34:35] offset:0 sc0 sc1
M_h0e:
  v_add_u32 v0, s61, v4
  v_add_u32 v1, 32, v0
  v_cvt_f32_u32 v1, v1
  v_mul_f32 v172, v1, v108
  v_mul_f32 v173, v1, v109
  v_mul_f32 v174, v1, v110
  v_mul_f32 v175, v1, v111
  v_mul_f32 v172, 0.15915494, v172
  v_mul_f32 v173, 0.15915494, v173
  v_mul_f32 v174, 0.15915494, v174
  v_mul_f32 v175, 0.15915494, v175
  v_fract_f32 v172, v172
  v_fract_f32 v173, v173
  v_fract_f32 v174, v174
  v_fract_f32 v175, v175
  v_sin_f32 v176, v172
  v_sin_f32 v177, v173
  v_sin_f32 v178, v174
  v_sin_f32 v179, v175
  v_cos_f32 v172, v172
  v_cos_f32 v173, v173
  v_cos_f32 v174, v174
  v_cos_f32 v175, v175
  v_cvt_pk_bf16_f32 v34, v176, v177
  v_cvt_pk_bf16_f32 v35, v178, v179
  v_cvt_pk_bf16_f32 v32, v172, v173
  v_cvt_pk_bf16_f32 v33, v174, v175
  v_lshlrev_b32 v172, 16, v32
  v_and_b32 v173, 0xffff0000, v32
  v_lshlrev_b32 v174, 16, v33
  v_and_b32 v175, 0xffff0000, v33
  v_lshlrev_b32 v176, 16, v34
  v_and_b32 v177, 0xffff0000, v34
  v_lshlrev_b32 v178, 16, v35
  v_and_b32 v179, 0xffff0000, v35
  v_add_u32 v1, 36, v0
  v_cvt_f32_u32 v1, v1
  v_mul_f32 v180, v1, v108
  v_mul_f32 v181, v1, v109
  v_mul_f32 v182, v1, v110
  v_mul_f32 v183, v1, v111
  v_mul_f32 v180, 0.15915494, v180
  v_mul_f32 v181, 0.15915494, v181
  v_mul_f32 v182, 0.15915494, v182
  v_mul_f32 v183, 0.15915494, v183
  v_fract_f32 v180, v180
  v_fract_f32 v181, v181
  v_fract_f32 v182, v182
  v_fract_f32 v183, v183
  v_sin_f32 v184, v180
  v_sin_f32 v185, v181
  v_sin_f32 v186, v182
  v_sin_f32 v187, v183
  v_cos_f32 v180, v180
  v_cos_f32 v181, v181
  v_cos_f32 v182, v182
  v_cos_f32 v183, v183
  v_cvt_pk_bf16_f32 v34, v184, v185
  v_cvt_pk_bf16_f32 v35, v186, v187
  v_cvt_pk_bf16_f32 v32, v180, v181
  v_cvt_pk_bf16_f32 v33, v182, v183
  v_lshlrev_b32 v180, 16, v32
  v_and_b32 v181, 0xffff0000, v32
  v_lshlrev_b32 v182, 16, v33
  v_and_b32 v183, 0xffff0000, v33
  v_lshlrev_b32 v184, 16, v34
  v_and_b32 v185, 0xffff0000, v34
  v_lshlrev_b32 v186, 16, v35
  v_and_b32 v187, 0xffff0000, v35
  s_lshr_b32 s58, s37, 1
  s_lshl_b32 s58, s58, 12
  s_and_b32 s59, s3, 1
  s_lshl_b32 s59, s59, 7
  s_add_u32 s58, s58, s59
  s_add_u32 s58, s58, 65536
  v_lshl_add_u32 v24, v3, 8, s58
  v_lshl_add_u32 v24, v4, 4, v24
  s_getreg_b32 s58, hwreg(HW_REG_XCC_ID, 0, 4)
  s_mul_i32 s58, s58, 0x01010101
  s_or_b32 s36, s58, 0x70707070
  s_lshl_b32 s58, s38, 5
  s_lshl_b32 s59, s3, 3
  s_add_u32 s59, s59, s58
  v_mov_b32 v255, s59
  s_add_u32 s58, s58, s39
  v_mov_b32 v5, s58
  s_cmp_lt_u32 s3, 2
  s_cbranch_scc0 M_h1b
  s_waitcnt vmcnt(12)
  s_waitcnt lgkmcnt(0)
  v_cvt_f32_i32 v76, v76
  v_cvt_f32_i32 v77, v77
  v_cvt_f32_i32 v78, v78
  v_cvt_f32_i32 v79, v79
  v_cvt_f32_i32 v80, v80
  v_cvt_f32_i32 v81, v81
  v_cvt_f32_i32 v82, v82
  v_cvt_f32_i32 v83, v83
  v_pk_fma_f32 v[76:77], v[76:77], v[192:193], v[192:193] op_sel:[0,0,1] op_sel_hi:[1,0,1] neg_lo:[0,0,1] neg_hi:[0,0,1]
  v_pk_fma_f32 v[78:79], v[78:79], v[192:193], v[192:193] op_sel:[0,0,1] op_sel_hi:[1,0,1] neg_lo:[0,0,1] neg_hi:[0,0,1]
  v_pk_fma_f32 v[80:81], v[80:81], v[194:195], v[194:195] op_sel:[0,0,1] op_sel_hi:[1,0,1] neg_lo:[0,0,1] neg_hi:[0,0,1]
  v_pk_fma_f32 v[82:83], v[82:83], v[194:195], v[194:195] op_sel:[0,0,1] op_sel_hi:[1,0,1] neg_lo:[0,0,1] neg_hi:[0,0,1]
  v_pk_mul_f32 v[28:29], v[76:77], v[156:157]
  v_pk_mul_f32 v[32:33], v[80:81], v[156:157]
  v_pk_mul_f32 v[30:31], v[78:79], v[158:159]
  v_pk_mul_f32 v[34:35], v[82:83], v[158:159]
  v_pk_fma_f32 v[28:29], v[80:81], v[160:161], v[28:29] neg_lo:[1,0,0] neg_hi:[1,0,0]
  v_pk_fma_f32 v[32:33], v[76:77], v[160:161], v[32:33]
  v_pk_fma_f32 v[30:31], v[82:83], v[162:163], v[30:31] neg_lo:[1,0,0] neg_hi:[1,0,0]
  v_pk_fma_f32 v[34:35], v[78:79], v[162:163], v[34:35]
  v_cvt_pk_bf16_f32 v76, v28, v29
  v_cvt_pk_bf16_f32 v77, v30, v31
  v_cvt_pk_bf16_f32 v78, v32, v33
  v_cvt_pk_bf16_f32 v79, v34, v35
  global_store_dwordx4 v22, v[76:79], s[34:35] offset:-4096 sc0 sc1
  ds_write_b128 v25, v[76:79]
  s_waitcnt vmcnt(11)
  v_cvt_f32_i32 v84, v84
  v_cvt_f32_i32 v85, v85
  v_cvt_f32_i32 v86, v86
  v_cvt_f32_i32 v87, v87
  v_cvt_f32_i32 v88, v88
  v_cvt_f32_i32 v89, v89
  v_cvt_f32_i32 v90, v90
  v_cvt_f32_i32 v91, v91
  v_pk_fma_f32 v[84:85], v[84:85], v[196:197], v[196:197] op_sel:[0,0,1] op_sel_hi:[1,0,1] neg_lo:[0,0,1] neg_hi:[0,0,1]
  v_pk_fma_f32 v[86:87], v[86:87], v[196:197], v[196:197] op_sel:[0,0,1] op_sel_hi:[1,0,1] neg_lo:[0,0,1] neg_hi:[0,0,1]
  v_pk_fma_f32 v[88:89], v[88:89], v[198:199], v[198:199] op_sel:[0,0,1] op_sel_hi:[1,0,1] neg_lo:[0,0,1] neg_hi:[0,0,1]
  v_pk_fma_f32 v[90:91], v[90:91], v[198:199], v[198:199] op_sel:[0,0,1] op_sel_hi:[1,0,1] neg_lo:[0,0,1] neg_hi:[0,0,1]
  v_pk_mul_f32 v[28:29], v[84:85], v[164:165]
  v_pk_mul_f32 v[32:33], v[88:89], v[164:165]
  v_pk_mul_f32 v[30:31], v[86:87], v[166:167]
  v_pk_mul_f32 v[34:35], v[90:91], v[166:167]
  v_pk_fma_f32 v[28:29], v[88:89], v[168:169], v[28:29] neg_lo:[1,0,0] neg_hi:[1,0,0]
  v_pk_fma_f32 v[32:33], v[84:85], v[168:169], v[32:33]
  v_pk_fma_f32 v[30:31], v[90:91], v[170:171], v[30:31] neg_lo:[1,0,0] neg_hi:[1,0,0]
  v_pk_fma_f32 v[34:35], v[86:87], v[170:171], v[34:35]
  v_cvt_pk_bf16_f32 v84, v28, v29
  v_cvt_pk_bf16_f32 v85, v30, v31
  v_cvt_pk_bf16_f32 v86, v32, v33
  v_cvt_pk_bf16_f32 v87, v34, v35
  global_store_dwordx4 v22, v[84:87], s[34:35] offset:0 sc0 sc1
  s_branch M_h1e
M_h1b:
  s_waitcnt vmcnt(16)
  v_cvt_f32_i32 v52, v52
  v_cvt_f32_i32 v53, v53
  v_cvt_f32_i32 v54, v54
  v_cvt_f32_i32 v55, v55
  v_subrev_f32_dpp v52, v189, v52 row_newbcast:0 row_mask:0xf bank_mask:0xf
  v_subrev_f32_dpp v53, v189, v53 row_newbcast:0 row_mask:0xf bank_mask:0xf
  v_subrev_f32_dpp v54, v189, v54 row_newbcast:1 row_mask:0xf bank_mask:0xf
  v_subrev_f32_dpp v55, v189, v55 row_newbcast:1 row_mask:0xf bank_mask:0xf
  v_mul_f32_dpp v52, v188, v52 row_newbcast:0 row_mask:0xf bank_mask:0xf
  v_mul_f32_dpp v53, v188, v53 row_newbcast:0 row_mask:0xf bank_mask:0xf
  v_mul_f32_dpp v54, v188, v54 row_newbcast:1 row_mask:0xf bank_mask:0xf
  v_mul_f32_dpp v55, v188, v55 row_newbcast:1 row_mask:0xf bank_mask:0xf
  v_cvt_pk_bf16_f32 v68, v52, v54
  v_cvt_pk_bf16_f32 v72, v53, v55
  s_waitcnt vmcnt(14)
  v_cvt_f32_i32 v56, v56
  v_cvt_f32_i32 v57, v57
  v_cvt_f32_i32 v58, v58
  v_cvt_f32_i32 v59, v59
  v_subrev_f32_dpp v56, v189, v56 row_newbcast:2 row_mask:0xf bank_mask:0xf
  v_subrev_f32_dpp v57, v189, v57 row_newbcast:2 row_mask:0xf bank_mask:0xf
  v_subrev_f32_dpp v58, v189, v58 row_newbcast:3 row_mask:0xf bank_mask:0xf
  v_subrev_f32_dpp v59, v189, v59 row_newbcast:3 row_mask:0xf bank_mask:0xf
  v_mul_f32_dpp v56, v188, v56 row_newbcast:2 row_mask:0xf bank_mask:0xf
  v_mul_f32_dpp v57, v188, v57 row_newbcast:2 row_mask:0xf bank_mask:0xf
  v_mul_f32_dpp v58, v188, v58 row_newbcast:3 row_mask:0xf bank_mask:0xf
  v_mul_f32_dpp v59, v188, v59 row_newbcast:3 row_mask:0xf bank_mask:0xf
  v_cvt_pk_bf16_f32 v69, v56, v58
  v_cvt_pk_bf16_f32 v73, v57, v59
  s_waitcnt vmcnt(12)
  v_cvt_f32_i32 v60, v60
  v_cvt_f32_i32 v61, v61
  v_cvt_f32_i32 v62, v62
  v_cvt_f32_i32 v63, v63
  v_subrev_f32_dpp v60, v189, v60 row_newbcast:4 row_mask:0xf bank_mask:0xf
  v_subrev_f32_dpp v61, v189, v61 row_newbcast:4 row_mask:0xf bank_mask:0xf
  v_subrev_f32_dpp v62, v189, v62 row_newbcast:5 row_mask:0xf bank_mask:0xf
  v_subrev_f32_dpp v63, v189, v63 row_newbcast:5 row_mask:0xf bank_mask:0xf
  v_mul_f32_dpp v60, v188, v60 row_newbcast:4 row_mask:0xf bank_mask:0xf
  v_mul_f32_dpp v61, v188, v61 row_newbcast:4 row_mask:0xf bank_mask:0xf
  v_mul_f32_dpp v62, v188, v62 row_newbcast:5 row_mask:0xf bank_mask:0xf
  v_mul_f32_dpp v63, v188, v63 row_newbcast:5 row_mask:0xf bank_mask:0xf
  v_cvt_pk_bf16_f32 v70, v60, v62
  v_cvt_pk_bf16_f32 v74, v61, v63
  s_waitcnt vmcnt(10)
  v_cvt_f32_i32 v64, v64
  v_cvt_f32_i32 v65, v65
  v_cvt_f32_i32 v66, v66
  v_cvt_f32_i32 v67, v67
  v_subrev_f32_dpp v64, v189, v64 row_newbcast:6 row_mask:0xf bank_mask:0xf
  v_subrev_f32_dpp v65, v189, v65 row_newbcast:6 row_mask:0xf bank_mask:0xf
  v_subrev_f32_dpp v66, v189, v66 row_newbcast:7 row_mask:0xf bank_mask:0xf
  v_subrev_f32_dpp v67, v189, v67 row_newbcast:7 row_mask:0xf bank_mask:0xf
  v_mul_f32_dpp v64, v188, v64 row_newbcast:6 row_mask:0xf bank_mask:0xf
  v_mul_f32_dpp v65, v188, v65 row_newbcast:6 row_mask:0xf bank_mask:0xf
  v_mul_f32_dpp v66, v188, v66 row_newbcast:7 row_mask:0xf bank_mask:0xf
  v_mul_f32_dpp v67, v188, v67 row_newbcast:7 row_mask:0xf bank_mask:0xf
  v_cvt_pk_bf16_f32 v71, v64, v66
  v_cvt_pk_bf16_f32 v75, v65, v67
  global_store_dwordx4 v23, v[68:71], s[34:35] offset:0 sc0 sc1
  global_store_dwordx4 v23, v[72:75], s[34:35] offset:1024 sc0 sc1
M_h1e:
  global_load_dwordx4 v[92:95], v15, s[10:11] offset:0
  global_load_dwordx4 v[96:99], v15, s[10:11] offset:256
  global_load_dwordx4 v[100:103], v15, s[10:11] offset:2048
  global_load_dwordx4 v[104:107], v15, s[10:11] offset:2304
  s_lshr_b32 s56, s39, 3
  s_lshl_b32 s56, s56, 18
  s_lshl_b32 s57, s38, 20
  s_add_u32 s56, s56, s57
  s_and_b32 s57, s39, 7
  s_lshl_b32 s57, s57, 14
  s_add_u32 s56, s56, s57
  s_add_u32 s56, s56, 0x20000
  s_lshl_b32 s57, s37, 8
  s_lshl_b32 s58, s3, 8
  s_add_u32 s57, s57, s56
  s_add_u32 s57, s57, 4096
  s_add_u32 s58, s58, s56
  s_add_u32 s58, s58, 8192
  v_lshrrev_b32 v0, 2, v3
  v_lshl_add_u32 v190, v0, 10, s57
  v_and_b32 v0, 3, v3
  v_lshl_add_u32 v190, v0, 6, v190
  v_lshl_add_u32 v190, v4, 4, v190
  v_lshrrev_b32 v0, 5, v2
  v_lshl_add_u32 v191, v0, 12, s58
  v_and_b32 v0, 1, v2
  v_lshl_add_u32 v191, v0, 11, v191
  v_bfe_u32 v0, v2, 1, 4
  v_lshl_add_u32 v191, v0, 4, v191
  s_waitcnt vmcnt(14)
  v_lshlrev_b32 v36, 16, v140
  v_and_b32 v37, 0xffff0000, v140
  v_lshlrev_b32 v38, 16, v141
  v_and_b32 v39, 0xffff0000, v141
  v_lshlrev_b32 v40, 16, v142
  v_and_b32 v41, 0xffff0000, v142
  v_lshlrev_b32 v42, 16, v143
  v_and_b32 v43, 0xffff0000, v143
  v_pk_mul_f32 v[28:29], v[36:37], v[156:157]
  v_pk_mul_f32 v[32:33], v[40:41], v[156:157]
  v_pk_mul_f32 v[30:31], v[38:39], v[158:159]
  v_pk_mul_f32 v[34:35], v[42:43], v[158:159]
  v_pk_fma_f32 v[28:29], v[40:41], v[160:161], v[28:29] neg_lo:[1,0,0] neg_hi:[1,0,0]
  v_pk_fma_f32 v[32:33], v[36:37], v[160:161], v[32:33]
  v_pk_fma_f32 v[30:31], v[42:43], v[162:163], v[30:31] neg_lo:[1,0,0] neg_hi:[1,0,0]
  v_pk_fma_f32 v[34:35], v[38:39], v[162:163], v[34:35]
  v_cvt_pk_bf16_f32 v44, v28, v29
  v_cvt_pk_bf16_f32 v45, v30, v31
  v_cvt_pk_bf16_f32 v46, v32, v33
  v_cvt_pk_bf16_f32 v47, v34, v35
  ds_write_b128 v24, v[44:47] offset:0
  s_waitcnt vmcnt(12)
  v_lshlrev_b32 v36, 16, v144
  v_and_b32 v37, 0xffff0000, v144
  v_lshlrev_b32 v38, 16, v145
  v_and_b32 v39, 0xffff0000, v145
  v_lshlrev_b32 v40, 16, v146
  v_and_b32 v41, 0xffff0000, v146
  v_lshlrev_b32 v42, 16, v147
  v_and_b32 v43, 0xffff0000, v147
  v_pk_mul_f32 v[28:29], v[36:37], v[164:165]
  v_pk_mul_f32 v[32:33], v[40:41], v[164:165]
  v_pk_mul_f32 v[30:31], v[38:39], v[166:167]
  v_pk_mul_f32 v[34:35], v[42:43], v[166:167]
  v_pk_fma_f32 v[28:29], v[40:41], v[168:169], v[28:29] neg_lo:[1,0,0] neg_hi:[1,0,0]
  v_pk_fma_f32 v[32:33], v[36:37], v[168:169], v[32:33]
  v_pk_fma_f32 v[30:31], v[42:43], v[170:171], v[30:31] neg_lo:[1,0,0] neg_hi:[1,0,0]
  v_pk_fma_f32 v[34:35], v[38:39], v[170:171], v[34:35]
  v_cvt_pk_bf16_f32 v48, v28, v29
  v_cvt_pk_bf16_f32 v49, v30, v31
  v_cvt_pk_bf16_f32 v50, v32, v33
  v_cvt_pk_bf16_f32 v51, v34, v35
  ds_write_b128 v24, v[48:51] offset:64
  s_waitcnt vmcnt(10)
  v_lshlrev_b32 v36, 16, v148
  v_and_b32 v37, 0xffff0000, v148
  v_lshlrev_b32 v38, 16, v149
  v_and_b32 v39, 0xffff0000, v149
  v_lshlrev_b32 v40, 16, v150
  v_and_b32 v41, 0xffff0000, v150
  v_lshlrev_b32 v42, 16, v151
  v_and_b32 v43, 0xffff0000, v151
  v_pk_mul_f32 v[28:29], v[36:37], v[172:173]
  v_pk_mul_f32 v[32:33], v[40:41], v[172:173]
  v_pk_mul_f32 v[30:31], v[38:39], v[174:175]
  v_pk_mul_f32 v[34:35], v[42:43], v[174:175]
  v_pk_fma_f32 v[28:29], v[40:41], v[176:177], v[28:29] neg_lo:[1,0,0] neg_hi:[1,0,0]
  v_pk_fma_f32 v[32:33], v[36:37], v[176:177], v[32:33]
  v_pk_fma_f32 v[30:31], v[42:43], v[178:179], v[30:31] neg_lo:[1,0,0] neg_hi:[1,0,0]
  v_pk_fma_f32 v[34:35], v[38:39], v[178:179], v[34:35]
  v_cvt_pk_bf16_f32 v44, v28, v29
  v_cvt_pk_bf16_f32 v45, v30, v31
  v_cvt_pk_bf16_f32 v46, v32, v33
  v_cvt_pk_bf16_f32 v47, v34, v35
  ds_write_b128 v24, v[44:47] offset:8192
  s_waitcnt vmcnt(8)
  v_lshlrev_b32 v36, 16, v152
  v_and_b32 v37, 0xffff0000, v152
  v_lshlrev_b32 v38, 16, v153
  v_and_b32 v39, 0xffff0000, v153
  v_lshlrev_b32 v40, 16, v154
  v_and_b32 v41, 0xffff0000, v154
  v_lshlrev_b32 v42, 16, v155
  v_and_b32 v43, 0xffff0000, v155
  v_pk_mul_f32 v[28:29], v[36:37], v[180:181]
  v_pk_mul_f32 v[32:33], v[40:41], v[180:181]
  v_pk_mul_f32 v[30:31], v[38:39], v[182:183]
  v_pk_mul_f32 v[34:35], v[42:43], v[182:183]
  v_pk_fma_f32 v[28:29], v[40:41], v[184:185], v[28:29] neg_lo:[1,0,0] neg_hi:[1,0,0]
  v_pk_fma_f32 v[32:33], v[36:37], v[184:185], v[32:33]
  v_pk_fma_f32 v[30:31], v[42:43], v[186:187], v[30:31] neg_lo:[1,0,0] neg_hi:[1,0,0]
  v_pk_fma_f32 v[34:35], v[38:39], v[186:187], v[34:35]
  v_cvt_pk_bf16_f32 v48, v28, v29
  v_cvt_pk_bf16_f32 v49, v30, v31
  v_cvt_pk_bf16_f32 v50, v32, v33
  v_cvt_pk_bf16_f32 v51, v34, v35
  ds_write_b128 v24, v[48:51] offset:8256
  s_waitcnt vmcnt(6)
  s_mov_b64 exec, 1
  ds_add_rtn_u32 v6, v242, v243 offset:0
  s_and_b32 s59, s36, 0x1f
  s_waitcnt lgkmcnt(0)
  v_readfirstlane_b32 s58, v6
  v_mov_b32 v6, s59
  s_nop 2
  s_cmp_eq_u32 s58, 3
  s_cbranch_scc0 M_pub0
  global_store_byte v5, v6, s[32:33]
M_pub0:
  s_mov_b64 exec, -1
  s_waitcnt lgkmcnt(0)
  s_barrier
  ds_read_b128 v[68:71], v238 offset:0
  ds_read_b128 a[128:131], v234 offset:0
  ds_read_b128 a[144:147], v235 offset:0
  ds_read_b128 a[160:163], v236 offset:0
  ds_read_b128 a[176:179], v237 offset:0
  ds_read_b128 v[72:75], v238 offset:1024
  ds_read_b128 a[132:135], v234 offset:1024
  ds_read_b128 a[148:151], v235 offset:1024
  ds_read_b128 a[164:167], v236 offset:1024
  ds_read_b128 a[180:183], v237 offset:1024
  ds_read_b128 v[76:79], v238 offset:2048
  ds_read_b128 a[136:139], v234 offset:2048
  ds_read_b128 a[152:155], v235 offset:2048
  ds_read_b128 a[168:171], v236 offset:2048
  ds_read_b128 a[184:187], v237 offset:2048
  s_waitcnt lgkmcnt(10)
  ds_read_b128 v[80:83], v238 offset:3072
  ds_read_b128 a[140:143], v234 offset:3072
  ds_read_b128 a[156:159], v235 offset:3072
  ds_read_b128 a[172:175], v236 offset:3072
  ds_read_b128 a[188:191], v237 offset:3072
  v_mfma_f32_16x16x32_bf16 v[52:55], v[68:71], a[128:131], 0
  v_mfma_f32_16x16x32_bf16 v[56:59], v[68:71], a[144:147], 0
  v_mfma_f32_16x16x32_bf16 v[60:63], v[68:71], a[160:163], 0
  v_mfma_f32_16x16x32_bf16 v[64:67], v[68:71], a[176:179], 0
  s_waitcnt lgkmcnt(10)
  v_mfma_f32_16x16x32_bf16 v[52:55], v[72:75], a[132:135], v[52:55]
  v_mfma_f32_16x16x32_bf16 v[56:59], v[72:75], a[148:151], v[56:59]
  v_mfma_f32_16x16x32_bf16 v[60:63], v[72:75], a[164:167], v[60:63]
  v_mfma_f32_16x16x32_bf16 v[64:67], v[72:75], a[180:183], v[64:67]
  s_waitcnt lgkmcnt(5)
  v_mfma_f32_16x16x32_bf16 v[52:55], v[76:79], a[136:139], v[52:55]
  v_mfma_f32_16x16x32_bf16 v[56:59], v[76:79], a[152:155], v[56:59]
  v_mfma_f32_16x16x32_bf16 v[60:63], v[76:79], a[168:171], v[60:63]
  v_mfma_f32_16x16x32_bf16 v[64:67], v[76:79], a[184:187], v[64:67]
  s_waitcnt lgkmcnt(0)
  v_mfma_f32_16x16x32_bf16 v[52:55], v[80:83], a[140:143], v[52:55]
  v_mfma_f32_16x16x32_bf16 v[56:59], v[80:83], a[156:159], v[56:59]
  v_mfma_f32_16x16x32_bf16 v[60:63], v[80:83], a[172:175], v[60:63]
  v_mfma_f32_16x16x32_bf16 v[64:67], v[80:83], a[188:191], v[64:67]
  s_nop 7
  v_min3_f32 v36, -v52, -v53, -v54
  v_min3_f32 v40, -v56, -v57, -v58
  v_min3_f32 v44, -v60, -v61, -v62
  v_min3_f32 v48, -v64, -v65, -v66
  v_min_f32_e64 v36, v36, -v55
  v_min_f32_e64 v40, v40, -v59
  v_min_f32_e64 v44, v44, -v63
  v_min_f32_e64 v48, v48, -v67
  v_mov_b32 v37, v36
  v_mov_b32 v38, v36
  v_mov_b32 v39, v36
  v_mov_b32 v41, v40
  v_mov_b32 v42, v40
  v_mov_b32 v43, v40
  v_mov_b32 v45, v44
  v_mov_b32 v46, v44
  v_mov_b32 v47, v44
  v_mov_b32 v49, v48
  v_mov_b32 v50, v48
  v_mov_b32 v51, v48
  global_load_dwordx2 v[0:1], v255, s[32:33] sc1
  global_load_dwordx2 v[208:209], v13, s[16:17] offset:0
  global_load_dwordx2 v[210:211], v13, s[16:17] offset:512
  global_load_dwordx2 v[212:213], v13, s[16:17] offset:1024
  global_load_dwordx2 v[214:215], v13, s[16:17] offset:1536
  global_load_dwordx2 v[216:217], v13, s[16:17] offset:2048
  global_load_dwordx2 v[218:219], v13, s[16:17] offset:2560
  global_load_dwordx2 v[220:221], v13, s[16:17] offset:3072
  global_load_dwordx2 v[222:223], v13, s[16:17] offset:3584
  s_waitcnt vmcnt(13)
  s_mov_b64 exec, 1
  ds_add_rtn_u32 v6, v242, v243 offset:4
  s_and_b32 s59, s36, 0x3f
  s_waitcnt lgkmcnt(0)
  v_readfirstlane_b32 s58, v6
  v_mov_b32 v6, s59
  s_nop 2
  s_cmp_eq_u32 s58, 3
  s_cbranch_scc0 M_pub1
  global_store_byte v5, v6, s[32:33]
M_pub1:
  s_mov_b64 exec, -1
  s_waitcnt vmcnt(11)
  v_cvt_f32_i32 v92, v92
  v_cvt_f32_i32 v93, v93
  v_cvt_f32_i32 v94, v94
  v_cvt_f32_i32 v95, v95
  v_cvt_f32_i32 v96, v96
  v_cvt_f32_i32 v97, v97
  v_cvt_f32_i32 v98, v98
  v_cvt_f32_i32 v99, v99
  v_pk_fma_f32 v[92:93], v[92:93], v[200:201], v[200:201] op_sel:[0,0,1] op_sel_hi:[1,0,1] neg_lo:[0,0,1] neg_hi:[0,0,1]
  v_pk_fma_f32 v[94:95], v[94:95], v[200:201], v[200:201] op_sel:[0,0,1] op_sel_hi:[1,0,1] neg_lo:[0,0,1] neg_hi:[0,0,1]
  v_pk_fma_f32 v[96:97], v[96:97], v[202:203], v[202:203] op_sel:[0,0,1] op_sel_hi:[1,0,1] neg_lo:[0,0,1] neg_hi:[0,0,1]
  v_pk_fma_f32 v[98:99], v[98:99], v[202:203], v[202:203] op_sel:[0,0,1] op_sel_hi:[1,0,1] neg_lo:[0,0,1] neg_hi:[0,0,1]
  v_pk_mul_f32 v[28:29], v[92:93], v[172:173]
  v_pk_mul_f32 v[32:33], v[96:97], v[172:173]
  v_pk_mul_f32 v[30:31], v[94:95], v[174:175]
  v_pk_mul_f32 v[34:35], v[98:99], v[174:175]
  v_pk_fma_f32 v[28:29], v[96:97], v[176:177], v[28:29] neg_lo:[1,0,0] neg_hi:[1,0,0]
  v_pk_fma_f32 v[32:33], v[92:93], v[176:177], v[32:33]
  v_pk_fma_f32 v[30:31], v[98:99], v[178:179], v[30:31] neg_lo:[1,0,0] neg_hi:[1,0,0]
  v_pk_fma_f32 v[34:35], v[94:95], v[178:179], v[34:35]
  v_cvt_pk_bf16_f32 v192, v28, v29
  v_cvt_pk_bf16_f32 v193, v30, v31
  v_cvt_pk_bf16_f32 v194, v32, v33
  v_cvt_pk_bf16_f32 v195, v34, v35
  s_waitcnt vmcnt(9)
  v_cvt_f32_i32 v100, v100
  v_cvt_f32_i32 v101, v101
  v_cvt_f32_i32 v102, v102
  v_cvt_f32_i32 v103, v103
  v_cvt_f32_i32 v104, v104
  v_cvt_f32_i32 v105, v105
  v_cvt_f32_i32 v106, v106
  v_cvt_f32_i32 v107, v107
  v_pk_fma_f32 v[100:101], v[100:101], v[204:205], v[204:205] op_sel:[0,0,1] op_sel_hi:[1,0,1] neg_lo:[0,0,1] neg_hi:[0,0,1]
  v_pk_fma_f32 v[102:103], v[102:103], v[204:205], v[204:205] op_sel:[0,0,1] op_sel_hi:[1,0,1] neg_lo:[0,0,1] neg_hi:[0,0,1]
  v_pk_fma_f32 v[104:105], v[104:105], v[206:207], v[206:207] op_sel:[0,0,1] op_sel_hi:[1,0,1] neg_lo:[0,0,1] neg_hi:[0,0,1]
  v_pk_fma_f32 v[106:107], v[106:107], v[206:207], v[206:207] op_sel:[0,0,1] op_sel_hi:[1,0,1] neg_lo:[0,0,1] neg_hi:[0,0,1]
  v_pk_mul_f32 v[28:29], v[100:101], v[180:181]
  v_pk_mul_f32 v[32:33], v[104:105], v[180:181]
  v_pk_mul_f32 v[30:31], v[102:103], v[182:183]
  v_pk_mul_f32 v[34:35], v[106:107], v[182:183]
  v_pk_fma_f32 v[28:29], v[104:105], v[184:185], v[28:29] neg_lo:[1,0,0] neg_hi:[1,0,0]
  v_pk_fma_f32 v[32:33], v[100:101], v[184:185], v[32:33]
  v_pk_fma_f32 v[30:31], v[106:107], v[186:187], v[30:31] neg_lo:[1,0,0] neg_hi:[1,0,0]
  v_pk_fma_f32 v[34:35], v[102:103], v[186:187], v[34:35]
  v_cvt_pk_bf16_f32 v196, v28, v29
  v_cvt_pk_bf16_f32 v197, v30, v31
  v_cvt_pk_bf16_f32 v198, v32, v33
  v_cvt_pk_bf16_f32 v199, v34, v35
  s_waitcnt vmcnt(8)
  v_readfirstlane_b32 s58, v0
  v_readfirstlane_b32 s59, v1
  s_nop 2
  s_xor_b32 s58, s58, s36
  s_xor_b32 s59, s59, s36
  s_or_b32 s58, s58, s59
  s_and_b32 s58, s58, 0x9f9f9f9f
  s_cbranch_scc1 M_late1
  buffer_load_dwordx4 a[0:3], v8, s[40:43], s48 offen offset:0 sc1
  buffer_load_dwordx4 a[4:7], v8, s[40:43], s48 offen offset:1024 sc1
  buffer_load_dwordx4 a[8:11], v8, s[40:43], s48 offen offset:2048 sc1
  buffer_load_dwordx4 a[12:15], v8, s[40:43], s48 offen offset:3072 sc1
  buffer_load_dwordx4 a[16:19], v9, s[40:43], s48 offen offset:0 sc1
  buffer_load_dwordx4 a[20:23], v9, s[40:43], s48 offen offset:1024 sc1
  buffer_load_dwordx4 a[24:27], v9, s[40:43], s48 offen offset:2048 sc1
  buffer_load_dwordx4 a[28:31], v9, s[40:43], s48 offen offset:3072 sc1
  buffer_load_dwordx4 a[32:35], v10, s[40:43], s48 offen offset:0 sc1
  buffer_load_dwordx4 a[36:39], v10, s[40:43], s48 offen offset:1024 sc1
  buffer_load_dwordx4 a[40:43], v10, s[40:43], s48 offen offset:2048 sc1
  buffer_load_dwordx4 a[44:47], v10, s[40:43], s48 offen offset:3072 sc1
  buffer_load_dwordx4 a[48:51], v11, s[40:43], s48 offen offset:0 sc1
  buffer_load_dwordx4 a[52:55], v11, s[40:43], s48 offen offset:1024 sc1
  buffer_load_dwordx4 a[56:59], v11, s[40:43], s48 offen offset:2048 sc1
  buffer_load_dwordx4 a[60:63], v11, s[40:43], s48 offen offset:3072 sc1
  s_add_u32 s48, s48, 0x4000
  buffer_load_dwordx4 a[64:67], v8, s[40:43], s48 offen offset:0 sc1
  buffer_load_dwordx4 a[68:71], v8, s[40:43], s48 offen offset:1024 sc1
  s_waitcnt vmcnt(24)
  v_cvt_f32_i32 v208, v208
  v_cvt_f32_i32 v209, v209
  v_cvt_f32_i32 v210, v210
  v_cvt_f32_i32 v211, v211
  v_subrev_f32_dpp v208, v189, v208 row_newbcast:8 row_mask:0xf bank_mask:0xf
  v_subrev_f32_dpp v209, v189, v209 row_newbcast:8 row_mask:0xf bank_mask:0xf
  v_subrev_f32_dpp v210, v189, v210 row_newbcast:9 row_mask:0xf bank_mask:0xf
  v_subrev_f32_dpp v211, v189, v211 row_newbcast:9 row_mask:0xf bank_mask:0xf
  v_mul_f32_dpp v208, v188, v208 row_newbcast:8 row_mask:0xf bank_mask:0xf
  v_mul_f32_dpp v209, v188, v209 row_newbcast:8 row_mask:0xf bank_mask:0xf
  v_mul_f32_dpp v210, v188, v210 row_newbcast:9 row_mask:0xf bank_mask:0xf
  v_mul_f32_dpp v211, v188, v211 row_newbcast:9 row_mask:0xf bank_mask:0xf
  v_cvt_pk_bf16_f32 v224, v208, v210
  v_cvt_pk_bf16_f32 v228, v209, v211
  s_waitcnt vmcnt(22)
  v_cvt_f32_i32 v212, v212
  v_cvt_f32_i32 v213, v213
  v_cvt_f32_i32 v214, v214
  v_cvt_f32_i32 v215, v215
  v_subrev_f32_dpp v212, v189, v212 row_newbcast:10 row_mask:0xf bank_mask:0xf
  v_subrev_f32_dpp v213, v189, v213 row_newbcast:10 row_mask:0xf bank_mask:0xf
  v_subrev_f32_dpp v214, v189, v214 row_newbcast:11 row_mask:0xf bank_mask:0xf
  v_subrev_f32_dpp v215, v189, v215 row_newbcast:11 row_mask:0xf bank_mask:0xf
  v_mul_f32_dpp v212, v188, v212 row_newbcast:10 row_mask:0xf bank_mask:0xf
  v_mul_f32_dpp v213, v188, v213 row_newbcast:10 row_mask:0xf bank_mask:0xf
  v_mul_f32_dpp v214, v188, v214 row_newbcast:11 row_mask:0xf bank_mask:0xf
  v_mul_f32_dpp v215, v188, v215 row_newbcast:11 row_mask:0xf bank_mask:0xf
  v_cvt_pk_bf16_f32 v225, v212, v214
  v_cvt_pk_bf16_f32 v229, v213, v215
  s_waitcnt vmcnt(20)
  v_cvt_f32_i32 v216, v216
  v_cvt_f32_i32 v217, v217
  v_cvt_f32_i32 v218, v218
  v_cvt_f32_i32 v219, v219
  v_subrev_f32_dpp v216, v189, v216 row_newbcast:12 row_mask:0xf bank_mask:0xf
  v_subrev_f32_dpp v217, v189, v217 row_newbcast:12 row_mask:0xf bank_mask:0xf
  v_subrev_f32_dpp v218, v189, v218 row_newbcast:13 row_mask:0xf bank_mask:0xf
  v_subrev_f32_dpp v219, v189, v219 row_newbcast:13 row_mask:0xf bank_mask:0xf
  v_mul_f32_dpp v216, v188, v216 row_newbcast:12 row_mask:0xf bank_mask:0xf
  v_mul_f32_dpp v217, v188, v217 row_newbcast:12 row_mask:0xf bank_mask:0xf
  v_mul_f32_dpp v218, v188, v218 row_newbcast:13 row_mask:0xf bank_mask:0xf
  v_mul_f32_dpp v219, v188, v219 row_newbcast:13 row_mask:0xf bank_mask:0xf
  v_cvt_pk_bf16_f32 v226, v216, v218
  v_cvt_pk_bf16_f32 v230, v217, v219
  s_waitcnt vmcnt(18)
  v_cvt_f32_i32 v220, v220
  v_cvt_f32_i32 v221, v221
  v_cvt_f32_i32 v222, v222
  v_cvt_f32_i32 v223, v223
  v_subrev_f32_dpp v220, v189, v220 row_newbcast:14 row_mask:0xf bank_mask:0xf
  v_subrev_f32_dpp v221, v189, v221 row_newbcast:14 row_mask:0xf bank_mask:0xf
  v_subrev_f32_dpp v222, v189, v222 row_newbcast:15 row_mask:0xf bank_mask:0xf
  v_subrev_f32_dpp v223, v189, v223 row_newbcast:15 row_mask:0xf bank_mask:0xf
  v_mul_f32_dpp v220, v188, v220 row_newbcast:14 row_mask:0xf bank_mask:0xf
  v_mul_f32_dpp v221, v188, v221 row_newbcast:14 row_mask:0xf bank_mask:0xf
  v_mul_f32_dpp v222, v188, v222 row_newbcast:15 row_mask:0xf bank_mask:0xf
  v_mul_f32_dpp v223, v188, v223 row_newbcast:15 row_mask:0xf bank_mask:0xf
  v_cvt_pk_bf16_f32 v227, v220, v222
  v_cvt_pk_bf16_f32 v231, v221, v223
M_k0:
  s_waitcnt vmcnt(14)
  v_mfma_f32_16x16x32_bf16 v[12:15], a[0:3], a[128:131], v[36:39]
  buffer_load_dwordx4 a[72:75], v8, s[40:43], s48 offen offset:2048 sc1
  v_mfma_f32_16x16x32_bf16 v[12:15], a[4:7], a[132:135], v[12:15]
  buffer_load_dwordx4 a[76:79], v8, s[40:43], s48 offen offset:3072 sc1
  v_mfma_f32_16x16x32_bf16 v[12:15], a[8:11], a[136:139], v[12:15]
  buffer_load_dwordx4 a[80:83], v9, s[40:43], s48 offen offset:0 sc1
  v_mfma_f32_16x16x32_bf16 v[12:15], a[12:15], a[140:143], v[12:15]
  buffer_load_dwordx4 a[84:87], v9, s[40:43], s48 offen offset:1024 sc1
  s_waitcnt vmcnt(14)
  v_mfma_f32_16x16x32_bf16 v[16:19], a[16:19], a[128:131], v[36:39]
  v_mfma_f32_16x16x32_bf16 v[16:19], a[20:23], a[132:135], v[16:19]
  v_mfma_f32_16x16x32_bf16 v[16:19], a[24:27], a[136:139], v[16:19]
  v_mfma_f32_16x16x32_bf16 v[16:19], a[28:31], a[140:143], v[16:19]
  global_load_dwordx2 v[0:1], v255, s[32:33] sc1
  global_store_dwordx4 v190, v[192:195], s[34:35] offset:-4096 sc0 sc1
  global_store_dwordx4 v190, v[196:199], s[34:35] offset:0 sc0 sc1
  global_store_dwordx4 v191, v[224:227], s[34:35] offset:0 sc0 sc1
  global_store_dwordx4 v191, v[228:231], s[34:35] offset:1024 sc0 sc1
  s_nop 2
M_go:
  v_mfma_f32_16x16x32_bf16 v[20:23], a[0:3], a[144:147], v[40:43]
  v_exp_f32 v12, v12
  v_exp_f32 v13, v13
  v_mfma_f32_16x16x32_bf16 v[20:23], a[4:7], a[148:151], v[20:23]
  buffer_load_dwordx4 a[88:91], v9, s[40:43], s48 offen offset:2048 sc1
  v_cvt_pk_bf16_f32 v28, v12, v13
  v_mfma_f32_16x16x32_bf16 v[20:23], a[8:11], a[152:155], v[20:23]
  v_exp_f32 v14, v14
  v_exp_f32 v15, v15
  v_mfma_f32_16x16x32_bf16 v[20:23], a[12:15], a[156:159], v[20:23]
  buffer_load_dwordx4 a[92:95], v9, s[40:43], s48 offen offset:3072 sc1
  v_cvt_pk_bf16_f32 v29, v14, v15
  v_mfma_f32_16x16x32_bf16 v[24:27], a[16:19], a[144:147], v[40:43]
  v_exp_f32 v16, v16
  v_exp_f32 v17, v17
  v_mfma_f32_16x16x32_bf16 v[24:27], a[20:23], a[148:151], v[24:27]
  buffer_load_dwordx4 a[96:99], v10, s[40:43], s48 offen offset:0 sc1
  v_cvt_pk_bf16_f32 v30, v16, v17
  v_mfma_f32_16x16x32_bf16 v[24:27], a[24:27], a[152:155], v[24:27]
  v_exp_f32 v18, v18
  v_exp_f32 v19, v19
  v_mfma_f32_16x16x32_bf16 v[24:27], a[28:31], a[156:159], v[24:27]
  buffer_load_dwordx4 a[100:103], v10, s[40:43], s48 offen offset:1024 sc1
  v_cvt_pk_bf16_f32 v31, v18, v19
  v_mfma_f32_16x16x32_bf16 v[12:15], a[0:3], a[160:163], v[44:47]
  v_exp_f32 v20, v20
  v_mfma_f32_16x16x32_bf16 v[12:15], a[4:7], a[164:167], v[12:15]
  v_exp_f32 v21, v21
  v_mfma_f32_16x16x32_bf16 v[12:15], a[8:11], a[168:171], v[12:15]
  buffer_load_dwordx4 a[104:107], v10, s[40:43], s48 offen offset:2048 sc1
  v_mfma_f32_16x16x32_bf16 v[12:15], a[12:15], a[172:175], v[12:15]
  v_cvt_pk_bf16_f32 v32, v20, v21
  v_mfma_f32_16x16x32_bf16 v[16:19], a[16:19], a[160:163], v[44:47]
  v_exp_f32 v22, v22
  v_mfma_f32_16x16x32_bf16 v[16:19], a[20:23], a[164:167], v[16:19]
  v_exp_f32 v23, v23
  v_mfma_f32_16x16x32_bf16 v[16:19], a[24:27], a[168:171], v[16:19]
  buffer_load_dwordx4 a[108:111], v10, s[40:43], s48 offen offset:3072 sc1
  v_mfma_f32_16x16x32_bf16 v[16:19], a[28:31], a[172:175], v[16:19]
  v_cvt_pk_bf16_f32 v33, v22, v23
  s_waitcnt vmcnt(16)
  v_mfma_f32_16x16x32_bf16 v[52:55], v[28:31], a[32:35], 0
  v_exp_f32 v24, v24
  v_mfma_f32_16x16x32_bf16 v[56:59], v[28:31], a[36:39], 0
  v_exp_f32 v25, v25
  v_mfma_f32_16x16x32_bf16 v[60:63], v[28:31], a[40:43], 0
  buffer_load_dwordx4 a[112:115], v11, s[40:43], s48 offen offset:0 sc1
  v_mfma_f32_16x16x32_bf16 v[64:67], v[28:31], a[44:47], 0
  v_cvt_pk_bf16_f32 v34, v24, v25
  s_waitcnt vmcnt(13)
  v_mfma_f32_16x16x32_bf16 v[68:71], v[28:31], a[48:51], 0
  v_exp_f32 v26, v26
  v_mfma_f32_16x16x32_bf16 v[72:75], v[28:31], a[52:55], 0
  v_exp_f32 v27, v27
  v_mfma_f32_16x16x32_bf16 v[76:79], v[28:31], a[56:59], 0
  buffer_load_dwordx4 a[116:119], v11, s[40:43], s48 offen offset:1024 sc1
  v_mfma_f32_16x16x32_bf16 v[80:83], v[28:31], a[60:63], 0
  v_cvt_pk_bf16_f32 v35, v26, v27
  v_mfma_f32_16x16x32_bf16 v[180:183], v[28:31], a[192:195], 0
  v_mfma_f32_16x16x32_bf16 v[20:23], a[0:3], a[176:179], v[48:51]
  v_exp_f32 v12, v12
  v_mfma_f32_16x16x32_bf16 v[20:23], a[4:7], a[180:183], v[20:23]
  v_exp_f32 v13, v13
  v_mfma_f32_16x16x32_bf16 v[20:23], a[8:11], a[184:187], v[20:23]
  buffer_load_dwordx4 a[120:123], v11, s[40:43], s48 offen offset:2048 sc1
  v_mfma_f32_16x16x32_bf16 v[20:23], a[12:15], a[188:191], v[20:23]
  v_cvt_pk_bf16_f32 v28, v12, v13
  v_mfma_f32_16x16x32_bf16 v[24:27], a[16:19], a[176:179], v[48:51]
  v_exp_f32 v14, v14
  v_mfma_f32_16x16x32_bf16 v[24:27], a[20:23], a[180:183], v[24:27]
  v_exp_f32 v15, v15
  v_mfma_f32_16x16x32_bf16 v[24:27], a[24:27], a[184:187], v[24:27]
  buffer_load_dwordx4 a[124:127], v11, s[40:43], s48 offen offset:3072 sc1
  v_mfma_f32_16x16x32_bf16 v[24:27], a[28:31], a[188:191], v[24:27]
  v_cvt_pk_bf16_f32 v29, v14, v15
  v_mfma_f32_16x16x32_bf16 v[84:87], v[32:35], a[32:35], 0
  v_exp_f32 v16, v16
  v_mfma_f32_16x16x32_bf16 v[88:91], v[32:35], a[36:39], 0
  v_exp_f32 v17, v17
  v_mfma_f32_16x16x32_bf16 v[92:95], v[32:35], a[40:43], 0
  s_add_u32 s48, s48, 0x4000
  buffer_load_dwordx4 a[0:3], v8, s[40:43], s48 offen offset:0 sc1
  v_mfma_f32_16x16x32_bf16 v[96:99], v[32:35], a[44:47], 0
  v_cvt_pk_bf16_f32 v30, v16, v17
  v_mfma_f32_16x16x32_bf16 v[100:103], v[32:35], a[48:51], 0
  v_exp_f32 v18, v18
  v_mfma_f32_16x16x32_bf16 v[104:107], v[32:35], a[52:55], 0
  v_exp_f32 v19, v19
  v_mfma_f32_16x16x32_bf16 v[108:111], v[32:35], a[56:59], 0
  buffer_load_dwordx4 a[4:7], v8, s[40:43], s48 offen offset:1024 sc1
  v_mfma_f32_16x16x32_bf16 v[112:115], v[32:35], a[60:63], 0
  v_cvt_pk_bf16_f32 v31, v18, v19
  v_mfma_f32_16x16x32_bf16 v[184:187], v[32:35], a[192:195], 0
  s_waitcnt vmcnt(14)
  v_mfma_f32_16x16x32_bf16 v[12:15], a[64:67], a[128:131], v[36:39]
  v_exp_f32 v20, v20
  v_mfma_f32_16x16x32_bf16 v[12:15], a[68:71], a[132:135], v[12:15]
  v_exp_f32 v21, v21
  v_mfma_f32_16x16x32_bf16 v[12:15], a[72:75], a[136:139], v[12:15]
  buffer_load_dwordx4 a[8:11], v8, s[40:43], s48 offen offset:2048 sc1
  v_mfma_f32_16x16x32_bf16 v[12:15], a[76:79], a[140:143], v[12:15]
  v_cvt_pk_bf16_f32 v32, v20, v21
  s_waitcnt vmcnt(11)
  v_mfma_f32_16x16x32_bf16 v[16:19], a[80:83], a[128:131], v[36:39]
  v_exp_f32 v22, v22
  v_mfma_f32_16x16x32_bf16 v[16:19], a[84:87], a[132:135], v[16:19]
  v_exp_f32 v23, v23
  v_mfma_f32_16x16x32_bf16 v[16:19], a[88:91], a[136:139], v[16:19]
  buffer_load_dwordx4 a[12:15], v8, s[40:43], s48 offen offset:3072 sc1
  v_mfma_f32_16x16x32_bf16 v[16:19], a[92:95], a[140:143], v[16:19]
  v_cvt_pk_bf16_f32 v33, v22, v23
  v_mfma_f32_16x16x32_bf16 v[116:119], v[28:31], a[32:35], 0
  v_exp_f32 v24, v24
  v_mfma_f32_16x16x32_bf16 v[120:123], v[28:31], a[36:39], 0
  v_exp_f32 v25, v25
  v_mfma_f32_16x16x32_bf16 v[124:127], v[28:31], a[40:43], 0
  buffer_load_dwordx4 a[16:19], v9, s[40:43], s48 offen offset:0 sc1
  v_mfma_f32_16x16x32_bf16 v[128:131], v[28:31], a[44:47], 0
  v_cvt_pk_bf16_f32 v34, v24, v25
  v_mfma_f32_16x16x32_bf16 v[132:135], v[28:31], a[48:51], 0
  v_exp_f32 v26, v26
  v_mfma_f32_16x16x32_bf16 v[136:139], v[28:31], a[52:55], 0
  v_exp_f32 v27, v27
  v_mfma_f32_16x16x32_bf16 v[140:143], v[28:31], a[56:59], 0
  buffer_load_dwordx4 a[20:23], v9, s[40:43], s48 offen offset:1024 sc1
  v_mfma_f32_16x16x32_bf16 v[144:147], v[28:31], a[60:63], 0
  v_cvt_pk_bf16_f32 v35, v26, v27
  v_mfma_f32_16x16x32_bf16 v[188:191], v[28:31], a[192:195], 0
  v_mfma_f32_16x16x32_bf16 v[20:23], a[64:67], a[144:147], v[40:43]
  v_exp_f32 v12, v12
  v_mfma_f32_16x16x32_bf16 v[20:23], a[68:71], a[148:151], v[20:23]
  v_exp_f32 v13, v13
  v_mfma_f32_16x16x32_bf16 v[20:23], a[72:75], a[152:155], v[20:23]
  buffer_load_dwordx4 a[24:27], v9, s[40:43], s48 offen offset:2048 sc1
  v_mfma_f32_16x16x32_bf16 v[20:23], a[76:79], a[156:159], v[20:23]
  v_cvt_pk_bf16_f32 v28, v12, v13
  v_mfma_f32_16x16x32_bf16 v[24:27], a[80:83], a[144:147], v[40:43]
  v_exp_f32 v14, v14
  v_mfma_f32_16x16x32_bf16 v[24:27], a[84:87], a[148:151], v[24:27]
  v_exp_f32 v15, v15
  v_mfma_f32_16x16x32_bf16 v[24:27], a[88:91], a[152:155], v[24:27]
  buffer_load_dwordx4 a[28:31], v9, s[40:43], s48 offen offset:3072 sc1
  v_mfma_f32_16x16x32_bf16 v[24:27], a[92:95], a[156:159], v[24:27]
  v_cvt_pk_bf16_f32 v29, v14, v15
  v_mfma_f32_16x16x32_bf16 v[148:151], v[32:35], a[32:35], 0
  v_exp_f32 v16, v16
  v_mfma_f32_16x16x32_bf16 v[152:155], v[32:35], a[36:39], 0
  v_exp_f32 v17, v17
  v_mfma_f32_16x16x32_bf16 v[156:159], v[32:35], a[40:43], 0
  buffer_load_dwordx4 a[32:35], v10, s[40:43], s48 offen offset:0 sc1
  v_mfma_f32_16x16x32_bf16 v[160:163], v[32:35], a[44:47], 0
  v_cvt_pk_bf16_f32 v30, v16, v17
  v_mfma_f32_16x16x32_bf16 v[164:167], v[32:35], a[48:51], 0
  v_exp_f32 v18, v18
  v_mfma_f32_16x16x32_bf16 v[168:171], v[32:35], a[52:55], 0
  v_exp_f32 v19, v19
  v_mfma_f32_16x16x32_bf16 v[172:175], v[32:35], a[56:59], 0
  buffer_load_dwordx4 a[36:39], v10, s[40:43], s48 offen offset:1024 sc1
  v_mfma_f32_16x16x32_bf16 v[176:179], v[32:35], a[60:63], 0
  v_cvt_pk_bf16_f32 v31, v18, v19
  v_mfma_f32_16x16x32_bf16 v[192:195], v[32:35], a[192:195], 0
  s_mov_b32 s49, 7
  s_cmp_lg_u32 s4, 0
  s_cbranch_scc1 M_loop
  s_mov_b32 s49, 1
  s_mov_b64 exec, 1
  ds_add_rtn_u32 v6, v242, v243 offset:8
  s_and_b32 s59, s36, 0x7f
  s_waitcnt lgkmcnt(0)
  v_readfirstlane_b32 s58, v6
  v_mov_b32 v6, s59
  s_nop 2
  s_cmp_eq_u32 s58, 3
  s_cbranch_scc0 M_pub2
  global_store_byte v5, v6, s[32:33]
M_pub2:
  s_mov_b64 exec, -1
  v_readfirstlane_b32 s58, v0
  v_readfirstlane_b32 s59, v1
  s_nop 2
  s_xor_b32 s58, s58, s36
  s_xor_b32 s59, s59, s36
  s_or_b32 s58, s58, s59
  s_and_b32 s58, s58, 0xbfbfbfbf
  s_cbranch_scc1 M_slow1
.p2align 3
M_loop:
  v_mfma_f32_16x16x32_bf16 v[12:15], a[64:67], a[160:163], v[44:47]
  v_exp_f32 v20, v20
  v_mfma_f32_16x16x32_bf16 v[12:15], a[68:71], a[164:167], v[12:15]
  v_exp_f32 v21, v21
  v_mfma_f32_16x16x32_bf16 v[12:15], a[72:75], a[168:171], v[12:15]
  buffer_load_dwordx4 a[40:43], v10, s[40:43], s48 offen offset:2048 sc1
  v_mfma_f32_16x16x32_bf16 v[12:15], a[76:79], a[172:175], v[12:15]
  v_cvt_pk_bf16_f32 v32, v20, v21
  v_mfma_f32_16x16x32_bf16 v[16:19], a[80:83], a[160:163], v[44:47]
  v_exp_f32 v22, v22
  v_mfma_f32_16x16x32_bf16 v[16:19], a[84:87], a[164:167], v[16:19]
  v_exp_f32 v23, v23
  v_mfma_f32_16x16x32_bf16 v[16:19], a[88:91], a[168:171], v[16:19]
  buffer_load_dwordx4 a[44:47], v10, s[40:43], s48 offen offset:3072 sc1
  v_mfma_f32_16x16x32_bf16 v[16:19], a[92:95], a[172:175], v[16:19]
  v_cvt_pk_bf16_f32 v33, v22, v23
  s_waitcnt vmcnt(16)
  v_mfma_f32_16x16x32_bf16 v[52:55], v[28:31], a[96:99], v[52:55]
  v_exp_f32 v24, v24
  v_mfma_f32_16x16x32_bf16 v[56:59], v[28:31], a[100:103], v[56:59]
  v_exp_f32 v25, v25
  v_mfma_f32_16x16x32_bf16 v[60:63], v[28:31], a[104:107], v[60:63]
  buffer_load_dwordx4 a[48:51], v11, s[40:43], s48 offen offset:0 sc1
  v_mfma_f32_16x16x32_bf16 v[64:67], v[28:31], a[108:111], v[64:67]
  v_cvt_pk_bf16_f32 v34, v24, v25
  s_waitcnt vmcnt(13)
  v_mfma_f32_16x16x32_bf16 v[68:71], v[28:31], a[112:115], v[68:71]
  v_exp_f32 v26, v26
  v_mfma_f32_16x16x32_bf16 v[72:75], v[28:31], a[116:119], v[72:75]
  v_exp_f32 v27, v27
  v_mfma_f32_16x16x32_bf16 v[76:79], v[28:31], a[120:123], v[76:79]
  buffer_load_dwordx4 a[52:55], v11, s[40:43], s48 offen offset:1024 sc1
  v_mfma_f32_16x16x32_bf16 v[80:83], v[28:31], a[124:127], v[80:83]
  v_cvt_pk_bf16_f32 v35, v26, v27
  v_mfma_f32_16x16x32_bf16 v[180:183], v[28:31], a[192:195], v[180:183]
  v_mfma_f32_16x16x32_bf16 v[20:23], a[64:67], a[176:179], v[48:51]
  v_exp_f32 v12, v12
  v_mfma_f32_16x16x32_bf16 v[20:23], a[68:71], a[180:183], v[20:23]
  v_exp_f32 v13, v13
  v_mfma_f32_16x16x32_bf16 v[20:23], a[72:75], a[184:187], v[20:23]
  buffer_load_dwordx4 a[56:59], v11, s[40:43], s48 offen offset:2048 sc1
  v_mfma_f32_16x16x32_bf16 v[20:23], a[76:79], a[188:191], v[20:23]
  v_cvt_pk_bf16_f32 v28, v12, v13
  v_mfma_f32_16x16x32_bf16 v[24:27], a[80:83], a[176:179], v[48:51]
  v_exp_f32 v14, v14
  v_mfma_f32_16x16x32_bf16 v[24:27], a[84:87], a[180:183], v[24:27]
  v_exp_f32 v15, v15
  v_mfma_f32_16x16x32_bf16 v[24:27], a[88:91], a[184:187], v[24:27]
  buffer_load_dwordx4 a[60:63], v11, s[40:43], s48 offen offset:3072 sc1
  v_mfma_f32_16x16x32_bf16 v[24:27], a[92:95], a[188:191], v[24:27]
  v_cvt_pk_bf16_f32 v29, v14, v15
  v_mfma_f32_16x16x32_bf16 v[84:87], v[32:35], a[96:99], v[84:87]
  v_exp_f32 v16, v16
  v_mfma_f32_16x16x32_bf16 v[88:91], v[32:35], a[100:103], v[88:91]
  v_exp_f32 v17, v17
  v_mfma_f32_16x16x32_bf16 v[92:95], v[32:35], a[104:107], v[92:95]
  s_add_u32 s48, s48, 0x4000
  buffer_load_dwordx4 a[64:67], v8, s[40:43], s48 offen offset:0 sc1
  v_mfma_f32_16x16x32_bf16 v[96:99], v[32:35], a[108:111], v[96:99]
  v_cvt_pk_bf16_f32 v30, v16, v17
  v_mfma_f32_16x16x32_bf16 v[100:103], v[32:35], a[112:115], v[100:103]
  v_exp_f32 v18, v18
  v_mfma_f32_16x16x32_bf16 v[104:107], v[32:35], a[116:119], v[104:107]
  v_exp_f32 v19, v19
  v_mfma_f32_16x16x32_bf16 v[108:111], v[32:35], a[120:123], v[108:111]
  buffer_load_dwordx4 a[68:71], v8, s[40:43], s48 offen offset:1024 sc1
  v_mfma_f32_16x16x32_bf16 v[112:115], v[32:35], a[124:127], v[112:115]
  v_cvt_pk_bf16_f32 v31, v18, v19
  v_mfma_f32_16x16x32_bf16 v[184:187], v[32:35], a[192:195], v[184:187]
  s_waitcnt vmcnt(14)
  v_mfma_f32_16x16x32_bf16 v[12:15], a[0:3], a[128:131], v[36:39]
  v_exp_f32 v20, v20
  v_mfma_f32_16x16x32_bf16 v[12:15], a[4:7], a[132:135], v[12:15]
  v_exp_f32 v21, v21
  v_mfma_f32_16x16x32_bf16 v[12:15], a[8:11], a[136:139], v[12:15]
  buffer_load_dwordx4 a[72:75], v8, s[40:43], s48 offen offset:2048 sc1
  v_mfma_f32_16x16x32_bf16 v[12:15], a[12:15], a[140:143], v[12:15]
  v_cvt_pk_bf16_f32 v32, v20, v21
  s_waitcnt vmcnt(11)
  v_mfma_f32_16x16x32_bf16 v[16:19], a[16:19], a[128:131], v[36:39]
  v_exp_f32 v22, v22
  v_mfma_f32_16x16x32_bf16 v[16:19], a[20:23], a[132:135], v[16:19]
  v_exp_f32 v23, v23
  v_mfma_f32_16x16x32_bf16 v[16:19], a[24:27], a[136:139], v[16:19]
  buffer_load_dwordx4 a[76:79], v8, s[40:43], s48 offen offset:3072 sc1
  v_mfma_f32_16x16x32_bf16 v[16:19], a[28:31], a[140:143], v[16:19]
  v_cvt_pk_bf16_f32 v33, v22, v23
  v_mfma_f32_16x16x32_bf16 v[116:119], v[28:31], a[96:99], v[116:119]
  v_exp_f32 v24, v24
  v_mfma_f32_16x16x32_bf16 v[120:123], v[28:31], a[100:103], v[120:123]
  v_exp_f32 v25, v25
  v_mfma_f32_16x16x32_bf16 v[124:127], v[28:31], a[104:107], v[124:127]
  buffer_load_dwordx4 a[80:83], v9, s[40:43], s48 offen offset:0 sc1
  v_mfma_f32_16x16x32_bf16 v[128:131], v[28:31], a[108:111], v[128:131]
  v_cvt_pk_bf16_f32 v34, v24, v25
  v_mfma_f32_16x16x32_bf16 v[132:135], v[28:31], a[112:115], v[132:135]
  v_exp_f32 v26, v26
  v_mfma_f32_16x16x32_bf16 v[136:139], v[28:31], a[116:119], v[136:139]
  v_exp_f32 v27, v27
  v_mfma_f32_16x16x32_bf16 v[140:143], v[28:31], a[120:123], v[140:143]
  buffer_load_dwordx4 a[84:87], v9, s[40:43], s48 offen offset:1024 sc1
  v_mfma_f32_16x16x32_bf16 v[144:147], v[28:31], a[124:127], v[144:147]
  v_cvt_pk_bf16_f32 v35, v26, v27
  v_mfma_f32_16x16x32_bf16 v[188:191], v[28:31], a[192:195], v[188:191]
  v_mfma_f32_16x16x32_bf16 v[20:23], a[0:3], a[144:147], v[40:43]
  v_exp_f32 v12, v12
  v_mfma_f32_16x16x32_bf16 v[20:23], a[4:7], a[148:151], v[20:23]
  v_exp_f32 v13, v13
  v_mfma_f32_16x16x32_bf16 v[20:23], a[8:11], a[152:155], v[20:23]
  buffer_load_dwordx4 a[88:91], v9, s[40:43], s48 offen offset:2048 sc1
  v_mfma_f32_16x16x32_bf16 v[20:23], a[12:15], a[156:159], v[20:23]
  v_cvt_pk_bf16_f32 v28, v12, v13
  v_mfma_f32_16x16x32_bf16 v[24:27], a[16:19], a[144:147], v[40:43]
  v_exp_f32 v14, v14
  v_mfma_f32_16x16x32_bf16 v[24:27], a[20:23], a[148:151], v[24:27]
  v_exp_f32 v15, v15
  v_mfma_f32_16x16x32_bf16 v[24:27], a[24:27], a[152:155], v[24:27]
  buffer_load_dwordx4 a[92:95], v9, s[40:43], s48 offen offset:3072 sc1
  v_mfma_f32_16x16x32_bf16 v[24:27], a[28:31], a[156:159], v[24:27]
  v_cvt_pk_bf16_f32 v29, v14, v15
  v_mfma_f32_16x16x32_bf16 v[148:151], v[32:35], a[96:99], v[148:151]
  v_exp_f32 v16, v16
  v_mfma_f32_16x16x32_bf16 v[152:155], v[32:35], a[100:103], v[152:155]
  v_exp_f32 v17, v17
  v_mfma_f32_16x16x32_bf16 v[156:159], v[32:35], a[104:107], v[156:159]
  buffer_load_dwordx4 a[96:99], v10, s[40:43], s48 offen offset:0 sc1
  v_mfma_f32_16x16x32_bf16 v[160:163], v[32:35], a[108:111], v[160:163]
  v_cvt_pk_bf16_f32 v30, v16, v17
  v_mfma_f32_16x16x32_bf16 v[164:167], v[32:35], a[112:115], v[164:167]
  v_exp_f32 v18, v18
  v_mfma_f32_16x16x32_bf16 v[168:171], v[32:35], a[116:119], v[168:171]
  v_exp_f32 v19, v19
  v_mfma_f32_16x16x32_bf16 v[172:175], v[32:35], a[120:123], v[172:175]
  buffer_load_dwordx4 a[100:103], v10, s[40:43], s48 offen offset:1024 sc1
  v_mfma_f32_16x16x32_bf16 v[176:179], v[32:35], a[124:127], v[176:179]
  v_cvt_pk_bf16_f32 v31, v18, v19
  v_mfma_f32_16x16x32_bf16 v[192:195], v[32:35], a[192:195], v[192:195]
  v_mfma_f32_16x16x32_bf16 v[12:15], a[0:3], a[160:163], v[44:47]
  v_exp_f32 v20, v20
  v_mfma_f32_16x16x32_bf16 v[12:15], a[4:7], a[164:167], v[12:15]
  v_exp_f32 v21, v21
  v_mfma_f32_16x16x32_bf16 v[12:15], a[8:11], a[168:171], v[12:15]
  buffer_load_dwordx4 a[104:107], v10, s[40:43], s48 offen offset:2048 sc1
  v_mfma_f32_16x16x32_bf16 v[12:15], a[12:15], a[172:175], v[12:15]
  v_cvt_pk_bf16_f32 v32, v20, v21
  v_mfma_f32_16x16x32_bf16 v[16:19], a[16:19], a[160:163], v[44:47]
  v_exp_f32 v22, v22
  v_mfma_f32_16x16x32_bf16 v[16:19], a[20:23], a[164:167], v[16:19]
  v_exp_f32 v23, v23
  v_mfma_f32_16x16x32_bf16 v[16:19], a[24:27], a[168:171], v[16:19]
  buffer_load_dwordx4 a[108:111], v10, s[40:43], s48 offen offset:3072 sc1
  v_mfma_f32_16x16x32_bf16 v[16:19], a[28:31], a[172:175], v[16:19]
  v_cvt_pk_bf16_f32 v33, v22, v23
  s_waitcnt vmcnt(16)
  v_mfma_f32_16x16x32_bf16 v[52:55], v[28:31], a[32:35], v[52:55]
  v_exp_f32 v24, v24
  v_mfma_f32_16x16x32_bf16 v[56:59], v[28:31], a[36:39], v[56:59]
  v_exp_f32 v25, v25
  v_mfma_f32_16x16x32_bf16 v[60:63], v[28:31], a[40:43], v[60:63]
  buffer_load_dwordx4 a[112:115], v11, s[40:43], s48 offen offset:0 sc1
  v_mfma_f32_16x16x32_bf16 v[64:67], v[28:31], a[44:47], v[64:67]
  v_cvt_pk_bf16_f32 v34, v24, v25
  s_waitcnt vmcnt(13)
  v_mfma_f32_16x16x32_bf16 v[68:71], v[28:31], a[48:51], v[68:71]
  v_exp_f32 v26, v26
  v_mfma_f32_16x16x32_bf16 v[72:75], v[28:31], a[52:55], v[72:75]
  v_exp_f32 v27, v27
  v_mfma_f32_16x16x32_bf16 v[76:79], v[28:31], a[56:59], v[76:79]
  buffer_load_dwordx4 a[116:119], v11, s[40:43], s48 offen offset:1024 sc1
  v_mfma_f32_16x16x32_bf16 v[80:83], v[28:31], a[60:63], v[80:83]
  v_cvt_pk_bf16_f32 v35, v26, v27
  v_mfma_f32_16x16x32_bf16 v[180:183], v[28:31], a[192:195], v[180:183]
  v_mfma_f32_16x16x32_bf16 v[20:23], a[0:3], a[176:179], v[48:51]
  v_exp_f32 v12, v12
  v_mfma_f32_16x16x32_bf16 v[20:23], a[4:7], a[180:183], v[20:23]
  v_exp_f32 v13, v13
  v_mfma_f32_16x16x32_bf16 v[20:23], a[8:11], a[184:187], v[20:23]
  buffer_load_dwordx4 a[120:123], v11, s[40:43], s48 offen offset:2048 sc1
  v_mfma_f32_16x16x32_bf16 v[20:23], a[12:15], a[188:191], v[20:23]
  v_cvt_pk_bf16_f32 v28, v12, v13
  v_mfma_f32_16x16x32_bf16 v[24:27], a[16:19], a[176:179], v[48:51]
  v_exp_f32 v14, v14
  v_mfma_f32_16x16x32_bf16 v[24:27], a[20:23], a[180:183], v[24:27]
  v_exp_f32 v15, v15
  v_mfma_f32_16x16x32_bf16 v[24:27], a[24:27], a[184:187], v[24:27]
  buffer_load_dwordx4 a[124:127], v11, s[40:43], s48 offen offset:3072 sc1
  v_mfma_f32_16x16x32_bf16 v[24:27], a[28:31], a[188:191], v[24:27]
  v_cvt_pk_bf16_f32 v29, v14, v15
  v_mfma_f32_16x16x32_bf16 v[84:87], v[32:35], a[32:35], v[84:87]
  v_exp_f32 v16, v16
  v_mfma_f32_16x16x32_bf16 v[88:91], v[32:35], a[36:39], v[88:91]
  v_exp_f32 v17, v17
  v_mfma_f32_16x16x32_bf16 v[92:95], v[32:35], a[40:43], v[92:95]
  s_add_u32 s48, s48, 0x4000
  buffer_load_dwordx4 a[0:3], v8, s[40:43], s48 offen offset:0 sc1
  v_mfma_f32_16x16x32_bf16 v[96:99], v[32:35], a[44:47], v[96:99]
  v_cvt_pk_bf16_f32 v30, v16, v17
  v_mfma_f32_16x16x32_bf16 v[100:103], v[32:35], a[48:51], v[100:103]
  v_exp_f32 v18, v18
  v_mfma_f32_16x16x32_bf16 v[104:107], v[32:35], a[52:55], v[104:107]
  v_exp_f32 v19, v19
  v_mfma_f32_16x16x32_bf16 v[108:111], v[32:35], a[56:59], v[108:111]
  buffer_load_dwordx4 a[4:7], v8, s[40:43], s48 offen offset:1024 sc1
  v_mfma_f32_16x16x32_bf16 v[112:115], v[32:35], a[60:63], v[112:115]
  v_cvt_pk_bf16_f32 v31, v18, v19
  v_mfma_f32_16x16x32_bf16 v[184:187], v[32:35], a[192:195], v[184:187]
  s_waitcnt vmcnt(14)
  v_mfma_f32_16x16x32_bf16 v[12:15], a[64:67], a[128:131], v[36:39]
  v_exp_f32 v20, v20
  v_mfma_f32_16x16x32_bf16 v[12:15], a[68:71], a[132:135], v[12:15]
  v_exp_f32 v21, v21
  v_mfma_f32_16x16x32_bf16 v[12:15], a[72:75], a[136:139], v[12:15]
  buffer_load_dwordx4 a[8:11], v8, s[40:43], s48 offen offset:2048 sc1
  v_mfma_f32_16x16x32_bf16 v[12:15], a[76:79], a[140:143], v[12:15]
  v_cvt_pk_bf16_f32 v32, v20, v21
  s_waitcnt vmcnt(11)
  v_mfma_f32_16x16x32_bf16 v[16:19], a[80:83], a[128:131], v[36:39]
  v_exp_f32 v22, v22
  v_mfma_f32_16x16x32_bf16 v[16:19], a[84:87], a[132:135], v[16:19]
  v_exp_f32 v23, v23
  v_mfma_f32_16x16x32_bf16 v[16:19], a[88:91], a[136:139], v[16:19]
  buffer_load_dwordx4 a[12:15], v8, s[40:43], s48 offen offset:3072 sc1
  v_mfma_f32_16x16x32_bf16 v[16:19], a[92:95], a[140:143], v[16:19]
  v_cvt_pk_bf16_f32 v33, v22, v23
  v_mfma_f32_16x16x32_bf16 v[116:119], v[28:31], a[32:35], v[116:119]
  v_exp_f32 v24, v24
  v_mfma_f32_16x16x32_bf16 v[120:123], v[28:31], a[36:39], v[120:123]
  v_exp_f32 v25, v25
  v_mfma_f32_16x16x32_bf16 v[124:127], v[28:31], a[40:43], v[124:127]
  buffer_load_dwordx4 a[16:19], v9, s[40:43], s48 offen offset:0 sc1
  v_mfma_f32_16x16x32_bf16 v[128:131], v[28:31], a[44:47], v[128:131]
  v_cvt_pk_bf16_f32 v34, v24, v25
  v_mfma_f32_16x16x32_bf16 v[132:135], v[28:31], a[48:51], v[132:135]
  v_exp_f32 v26, v26
  v_mfma_f32_16x16x32_bf16 v[136:139], v[28:31], a[52:55], v[136:139]
  v_exp_f32 v27, v27
  v_mfma_f32_16x16x32_bf16 v[140:143], v[28:31], a[56:59], v[140:143]
  buffer_load_dwordx4 a[20:23], v9, s[40:43], s48 offen offset:1024 sc1
  v_mfma_f32_16x16x32_bf16 v[144:147], v[28:31], a[60:63], v[144:147]
  v_cvt_pk_bf16_f32 v35, v26, v27
  v_mfma_f32_16x16x32_bf16 v[188:191], v[28:31], a[192:195], v[188:191]
  v_mfma_f32_16x16x32_bf16 v[20:23], a[64:67], a[144:147], v[40:43]
  v_exp_f32 v12, v12
  v_mfma_f32_16x16x32_bf16 v[20:23], a[68:71], a[148:151], v[20:23]
  v_exp_f32 v13, v13
  v_mfma_f32_16x16x32_bf16 v[20:23], a[72:75], a[152:155], v[20:23]
  buffer_load_dwordx4 a[24:27], v9, s[40:43], s48 offen offset:2048 sc1
  v_mfma_f32_16x16x32_bf16 v[20:23], a[76:79], a[156:159], v[20:23]
  v_cvt_pk_bf16_f32 v28, v12, v13
  v_mfma_f32_16x16x32_bf16 v[24:27], a[80:83], a[144:147], v[40:43]
  v_exp_f32 v14, v14
  v_mfma_f32_16x16x32_bf16 v[24:27], a[84:87], a[148:151], v[24:27]
  v_exp_f32 v15, v15
  v_mfma_f32_16x16x32_bf16 v[24:27], a[88:91], a[152:155], v[24:27]
  buffer_load_dwordx4 a[28:31], v9, s[40:43], s48 offen offset:3072 sc1
  v_mfma_f32_16x16x32_bf16 v[24:27], a[92:95], a[156:159], v[24:27]
  v_cvt_pk_bf16_f32 v29, v14, v15
  v_mfma_f32_16x16x32_bf16 v[148:151], v[32:35], a[32:35], v[148:151]
  v_exp_f32 v16, v16
  v_mfma_f32_16x16x32_bf16 v[152:155], v[32:35], a[36:39], v[152:155]
  v_exp_f32 v17, v17
  v_mfma_f32_16x16x32_bf16 v[156:159], v[32:35], a[40:43], v[156:159]
  buffer_load_dwordx4 a[32:35], v10, s[40:43], s48 offen offset:0 sc1
  v_mfma_f32_16x16x32_bf16 v[160:163], v[32:35], a[44:47], v[160:163]
  v_cvt_pk_bf16_f32 v30, v16, v17
  v_mfma_f32_16x16x32_bf16 v[164:167], v[32:35], a[48:51], v[164:167]
  v_exp_f32 v18, v18
  v_mfma_f32_16x16x32_bf16 v[168:171], v[32:35], a[52:55], v[168:171]
  v_exp_f32 v19, v19
  v_mfma_f32_16x16x32_bf16 v[172:175], v[32:35], a[56:59], v[172:175]
  buffer_load_dwordx4 a[36:39], v10, s[40:43], s48 offen offset:1024 sc1
  v_mfma_f32_16x16x32_bf16 v[176:179], v[32:35], a[60:63], v[176:179]
  v_cvt_pk_bf16_f32 v31, v18, v19
  s_sub_u32 s49, s49, 1
  s_cmp_lg_u32 s49, 0
  v_mfma_f32_16x16x32_bf16 v[192:195], v[32:35], a[192:195], v[192:195]
  s_cbranch_scc1 M_loop
  s_cmp_lt_u32 s4, 2
  s_cbranch_scc0 M_tail
  s_add_u32 s4, s4, 1
  s_cmp_eq_u32 s4, 1
  s_cbranch_scc0 M_hook2
  s_mov_b32 s49, 1
  global_load_dwordx2 v[0:1], v255, s[32:33] sc1
  s_branch M_loop
M_hook2:
  s_mov_b32 s49, 5
  v_readfirstlane_b32 s58, v0
  v_readfirstlane_b32 s59, v1
  s_nop 2
  s_xor_b32 s58, s58, s36
  s_xor_b32 s59, s59, s36
  s_or_b32 s58, s58, s59
  s_cbranch_scc0 M_loop
  s_branch M_slow2
M_tail:
  v_mfma_f32_16x16x32_bf16 v[12:15], a[64:67], a[160:163], v[44:47]
  v_exp_f32 v20, v20
  v_mfma_f32_16x16x32_bf16 v[12:15], a[68:71], a[164:167], v[12:15]
  v_exp_f32 v21, v21
  v_mfma_f32_16x16x32_bf16 v[12:15], a[72:75], a[168:171], v[12:15]
  v_mfma_f32_16x16x32_bf16 v[12:15], a[76:79], a[172:175], v[12:15]
  v_cvt_pk_bf16_f32 v32, v20, v21
  v_mfma_f32_16x16x32_bf16 v[16:19], a[80:83], a[160:163], v[44:47]
  v_exp_f32 v22, v22
  v_mfma_f32_16x16x32_bf16 v[16:19], a[84:87], a[164:167], v[16:19]
  v_exp_f32 v23, v23
  v_mfma_f32_16x16x32_bf16 v[16:19], a[88:91], a[168:171], v[16:19]
  v_mfma_f32_16x16x32_bf16 v[16:19], a[92:95], a[172:175], v[16:19]
  v_cvt_pk_bf16_f32 v33, v22, v23
  s_waitcnt vmcnt(14)
  v_mfma_f32_16x16x32_bf16 v[52:55], v[28:31], a[96:99], v[52:55]
  v_exp_f32 v24, v24
  v_mfma_f32_16x16x32_bf16 v[56:59], v[28:31], a[100:103], v[56:59]
  v_exp_f32 v25, v25
  v_mfma_f32_16x16x32_bf16 v[60:63], v[28:31], a[104:107], v[60:63]
  v_mfma_f32_16x16x32_bf16 v[64:67], v[28:31], a[108:111], v[64:67]
  v_cvt_pk_bf16_f32 v34, v24, v25
  s_waitcnt vmcnt(10)
  v_mfma_f32_16x16x32_bf16 v[68:71], v[28:31], a[112:115], v[68:71]
  v_exp_f32 v26, v26
  v_mfma_f32_16x16x32_bf16 v[72:75], v[28:31], a[116:119], v[72:75]
  v_exp_f32 v27, v27
  v_mfma_f32_16x16x32_bf16 v[76:79], v[28:31], a[120:123], v[76:79]
  v_mfma_f32_16x16x32_bf16 v[80:83], v[28:31], a[124:127], v[80:83]
  v_cvt_pk_bf16_f32 v35, v26, v27
  v_mfma_f32_16x16x32_bf16 v[180:183], v[28:31], a[192:195], v[180:183]
  v_mfma_f32_16x16x32_bf16 v[20:23], a[64:67], a[176:179], v[48:51]
  v_exp_f32 v12, v12
  v_mfma_f32_16x16x32_bf16 v[20:23], a[68:71], a[180:183], v[20:23]
  v_exp_f32 v13, v13
  v_mfma_f32_16x16x32_bf16 v[20:23], a[72:75], a[184:187], v[20:23]
  v_cvt_pk_bf16_f32 v196, v52, v53
  v_cvt_pk_bf16_f32 v197, v54, v55
  v_mfma_f32_16x16x32_bf16 v[20:23], a[76:79], a[188:191], v[20:23]
  v_cvt_pk_bf16_f32 v198, v56, v57
  v_cvt_pk_bf16_f32 v28, v12, v13
  v_mfma_f32_16x16x32_bf16 v[24:27], a[80:83], a[176:179], v[48:51]
  v_cvt_pk_bf16_f32 v199, v58, v59
  v_exp_f32 v14, v14
  v_mfma_f32_16x16x32_bf16 v[24:27], a[84:87], a[180:183], v[24:27]
  ds_write_b128 v252, v[196:199] offset:4096
  v_exp_f32 v15, v15
  v_mfma_f32_16x16x32_bf16 v[24:27], a[88:91], a[184:187], v[24:27]
  v_cvt_pk_bf16_f32 v200, v60, v61
  v_cvt_pk_bf16_f32 v201, v62, v63
  v_mfma_f32_16x16x32_bf16 v[24:27], a[92:95], a[188:191], v[24:27]
  v_cvt_pk_bf16_f32 v202, v64, v65
  v_cvt_pk_bf16_f32 v29, v14, v15
  v_mfma_f32_16x16x32_bf16 v[84:87], v[32:35], a[96:99], v[84:87]
  v_cvt_pk_bf16_f32 v203, v66, v67
  v_exp_f32 v16, v16
  v_mfma_f32_16x16x32_bf16 v[88:91], v[32:35], a[100:103], v[88:91]
  ds_write_b128 v252, v[200:203] offset:5120
  v_exp_f32 v17, v17
  v_mfma_f32_16x16x32_bf16 v[92:95], v[32:35], a[104:107], v[92:95]
  v_cvt_pk_bf16_f32 v204, v68, v69
  v_cvt_pk_bf16_f32 v205, v70, v71
  v_mfma_f32_16x16x32_bf16 v[96:99], v[32:35], a[108:111], v[96:99]
  v_cvt_pk_bf16_f32 v206, v72, v73
  v_cvt_pk_bf16_f32 v30, v16, v17
  v_mfma_f32_16x16x32_bf16 v[100:103], v[32:35], a[112:115], v[100:103]
  v_cvt_pk_bf16_f32 v207, v74, v75
  v_exp_f32 v18, v18
  v_mfma_f32_16x16x32_bf16 v[104:107], v[32:35], a[116:119], v[104:107]
  ds_write_b128 v252, v[204:207] offset:6144
  v_exp_f32 v19, v19
  v_mfma_f32_16x16x32_bf16 v[108:111], v[32:35], a[120:123], v[108:111]
  v_cvt_pk_bf16_f32 v208, v76, v77
  v_cvt_pk_bf16_f32 v209, v78, v79
  v_mfma_f32_16x16x32_bf16 v[112:115], v[32:35], a[124:127], v[112:115]
  v_cvt_pk_bf16_f32 v210, v80, v81
  v_cvt_pk_bf16_f32 v31, v18, v19
  v_mfma_f32_16x16x32_bf16 v[184:187], v[32:35], a[192:195], v[184:187]
  v_cvt_pk_bf16_f32 v211, v82, v83
  ds_write_b128 v252, v[208:211] offset:7168
  s_nop 0
  v_mfma_f32_16x16x32_bf16 v[116:119], v[28:31], a[96:99], v[116:119]
  ds_write_b128 v252, v[180:183] offset:1024
  v_exp_f32 v20, v20
  v_exp_f32 v21, v21
  v_mfma_f32_16x16x32_bf16 v[120:123], v[28:31], a[100:103], v[120:123]
  v_add_f32 v244, v180, v182
  v_cvt_pk_bf16_f32 v32, v20, v21
  v_mfma_f32_16x16x32_bf16 v[124:127], v[28:31], a[104:107], v[124:127]
  v_add_f32 v245, v181, v183
  v_exp_f32 v22, v22
  v_exp_f32 v23, v23
  v_mfma_f32_16x16x32_bf16 v[128:131], v[28:31], a[108:111], v[128:131]
  v_cvt_pk_bf16_f32 v212, v84, v85
  v_cvt_pk_bf16_f32 v33, v22, v23
  v_mfma_f32_16x16x32_bf16 v[132:135], v[28:31], a[112:115], v[132:135]
  v_cvt_pk_bf16_f32 v213, v86, v87
  v_exp_f32 v24, v24
  v_exp_f32 v25, v25
  v_mfma_f32_16x16x32_bf16 v[136:139], v[28:31], a[116:119], v[136:139]
  v_cvt_pk_bf16_f32 v214, v88, v89
  v_cvt_pk_bf16_f32 v34, v24, v25
  v_mfma_f32_16x16x32_bf16 v[140:143], v[28:31], a[120:123], v[140:143]
  v_cvt_pk_bf16_f32 v215, v90, v91
  v_exp_f32 v26, v26
  v_exp_f32 v27, v27
  v_mfma_f32_16x16x32_bf16 v[144:147], v[28:31], a[124:127], v[144:147]
  ds_write_b128 v253, v[212:215] offset:8192
  v_cvt_pk_bf16_f32 v35, v26, v27
  v_mfma_f32_16x16x32_bf16 v[188:191], v[28:31], a[192:195], v[188:191]
  v_cvt_pk_bf16_f32 v216, v92, v93
  s_nop 1
  v_mfma_f32_16x16x32_bf16 v[148:151], v[32:35], a[96:99], v[148:151]
  v_cvt_pk_bf16_f32 v217, v94, v95
  v_cvt_pk_bf16_f32 v218, v96, v97
  v_mfma_f32_16x16x32_bf16 v[152:155], v[32:35], a[100:103], v[152:155]
  v_cvt_pk_bf16_f32 v219, v98, v99
  ds_write_b128 v253, v[216:219] offset:9216
  v_mfma_f32_16x16x32_bf16 v[156:159], v[32:35], a[104:107], v[156:159]
  v_cvt_pk_bf16_f32 v220, v100, v101
  v_cvt_pk_bf16_f32 v221, v102, v103
  v_mfma_f32_16x16x32_bf16 v[160:163], v[32:35], a[108:111], v[160:163]
  v_cvt_pk_bf16_f32 v222, v104, v105
  v_cvt_pk_bf16_f32 v223, v106, v107
  v_mfma_f32_16x16x32_bf16 v[164:167], v[32:35], a[112:115], v[164:167]
  ds_write_b128 v253, v[220:223] offset:10240
  v_cvt_pk_bf16_f32 v224, v108, v109
  v_mfma_f32_16x16x32_bf16 v[168:171], v[32:35], a[116:119], v[168:171]
  v_cvt_pk_bf16_f32 v225, v110, v111
  v_cvt_pk_bf16_f32 v226, v112, v113
  v_mfma_f32_16x16x32_bf16 v[172:175], v[32:35], a[120:123], v[172:175]
  v_cvt_pk_bf16_f32 v227, v114, v115
  ds_write_b128 v253, v[224:227] offset:11264
  v_mfma_f32_16x16x32_bf16 v[176:179], v[32:35], a[124:127], v[176:179]
  ds_write_b128 v253, v[184:187] offset:2048
  v_add_f32 v246, v184, v186
  v_mfma_f32_16x16x32_bf16 v[192:195], v[32:35], a[192:195], v[192:195]
  v_add_f32 v247, v185, v187
  v_cvt_pk_bf16_f32 v196, v116, v117
  v_cvt_pk_bf16_f32 v197, v118, v119
  v_cvt_pk_bf16_f32 v198, v120, v121
  v_cvt_pk_bf16_f32 v199, v122, v123
  ds_write_b128 v254, v[196:199] offset:12288
  v_cvt_pk_bf16_f32 v200, v124, v125
  v_cvt_pk_bf16_f32 v201, v126, v127
  v_cvt_pk_bf16_f32 v202, v128, v129
  v_cvt_pk_bf16_f32 v203, v130, v131
  ds_write_b128 v254, v[200:203] offset:13312
  v_cvt_pk_bf16_f32 v204, v132, v133
  v_cvt_pk_bf16_f32 v205, v134, v135
  v_cvt_pk_bf16_f32 v206, v136, v137
  v_cvt_pk_bf16_f32 v207, v138, v139
  ds_write_b128 v254, v[204:207] offset:14336
  v_cvt_pk_bf16_f32 v208, v140, v141
  v_cvt_pk_bf16_f32 v209, v142, v143
  v_cvt_pk_bf16_f32 v210, v144, v145
  v_cvt_pk_bf16_f32 v211, v146, v147
  ds_write_b128 v254, v[208:211] offset:15360
  ds_write_b128 v254, v[188:191] offset:3072
  v_add_f32 v248, v188, v190
  v_add_f32 v249, v189, v191
  v_pk_add_f32 v[244:245], v[244:245], v[246:247]
  v_pk_add_f32 v[244:245], v[244:245], v[248:249]
  v_pk_add_f32 v[250:251], v[192:193], v[194:195]
  v_pk_add_f32 v[244:245], v[244:245], v[250:251]
  s_mov_b32 s58, 0x4b800000
  v_add_f32 v244, v244, v245
  v_cmp_ngt_f32 vcc, s58, v244
  s_nop 4
  s_cbranch_vccnz M_vote
M_voted:
  s_waitcnt lgkmcnt(0)
  s_barrier
  ds_read_b128 v[52:55], v241 offset:4096
  ds_read_b128 v[56:59], v241 offset:8192
  ds_read_b128 v[60:63], v241 offset:12288
  ds_read_b32 v112, v242 offset:12
  ds_read_b128 v[100:103], v241 offset:1024
  ds_read_b128 v[104:107], v241 offset:2048
  ds_read_b128 v[108:111], v241 offset:3072
  s_waitcnt lgkmcnt(6)
  v_mfma_f32_16x16x32_bf16 v[148:151], a[198:201], v[52:55], v[148:151]
  ds_read_b128 v[64:67], v241 offset:5120
  v_mfma_f32_16x16x32_bf16 v[152:155], a[196:199], v[52:55], v[152:155]
  ds_read_b128 v[68:71], v241 offset:9216
  s_waitcnt lgkmcnt(7)
  v_mfma_f32_16x16x32_bf16 v[148:151], a[198:201], v[56:59], v[148:151]
  ds_read_b128 v[72:75], v241 offset:13312
  v_mfma_f32_16x16x32_bf16 v[152:155], a[196:199], v[56:59], v[152:155]
  ds_read_b128 v[76:79], v241 offset:6144
  s_waitcnt lgkmcnt(8)
  v_mfma_f32_16x16x32_bf16 v[148:151], a[198:201], v[60:63], v[148:151]
  ds_read_b128 v[80:83], v241 offset:10240
  v_mfma_f32_16x16x32_bf16 v[152:155], a[196:199], v[60:63], v[152:155]
  ds_read_b128 v[84:87], v241 offset:14336
  s_waitcnt lgkmcnt(6)
  v_cmp_lt_u32 vcc, s50, v112
  s_waitcnt lgkmcnt(5)
  v_mfma_f32_16x16x32_bf16 v[156:159], a[198:201], v[64:67], v[156:159]
  ds_read_b128 v[88:91], v241 offset:7168
  v_add_f32 v192, v192, v100
  v_add_f32 v193, v193, v101
  v_add_f32 v194, v194, v102
  v_mfma_f32_16x16x32_bf16 v[160:163], a[196:199], v[64:67], v[160:163]
  ds_read_b128 v[92:95], v241 offset:11264
  v_add_f32 v195, v195, v103
  v_add_f32 v192, v192, v104
  v_add_f32 v193, v193, v105
  s_waitcnt lgkmcnt(6)
  v_mfma_f32_16x16x32_bf16 v[156:159], a[198:201], v[68:71], v[156:159]
  ds_read_b128 v[96:99], v241 offset:15360
  v_add_f32 v194, v194, v106
  v_add_f32 v195, v195, v107
  v_add_f32 v192, v192, v108
  v_mfma_f32_16x16x32_bf16 v[160:163], a[196:199], v[68:71], v[160:163]
  v_add_f32 v193, v193, v109
  v_add_f32 v194, v194, v110
  v_add_f32 v195, v195, v111
  s_waitcnt lgkmcnt(6)
  v_mfma_f32_16x16x32_bf16 v[156:159], a[198:201], v[72:75], v[156:159]
  v_rcp_f32 v192, v192
  v_rcp_f32 v193, v193
  v_rcp_f32 v194, v194
  v_mfma_f32_16x16x32_bf16 v[160:163], a[196:199], v[72:75], v[160:163]
  v_rcp_f32 v195, v195
  s_cbranch_vccnz M_fallback
  s_waitcnt lgkmcnt(5)
  v_mfma_f32_16x16x32_bf16 v[164:167], a[198:201], v[76:79], v[164:167]
  v_mul_f32 v148, v192, v148
  v_mul_f32 v149, v193, v149
  v_mul_f32 v150, v194, v150
  v_mfma_f32_16x16x32_bf16 v[168:171], a[196:199], v[76:79], v[168:171]
  v_mul_f32 v151, v195, v151
  v_mul_f32 v152, v192, v152
  v_mul_f32 v153, v193, v153
  s_waitcnt lgkmcnt(4)
  v_mfma_f32_16x16x32_bf16 v[164:167], a[198:201], v[80:83], v[164:167]
  v_mul_f32 v154, v194, v154
  v_mul_f32 v155, v195, v155
  v_cvt_pk_bf16_f32 v196, v148, v152
  v_mfma_f32_16x16x32_bf16 v[168:171], a[196:199], v[80:83], v[168:171]
  v_cvt_pk_bf16_f32 v200, v149, v153
  v_cvt_pk_bf16_f32 v204, v150, v154
  v_cvt_pk_bf16_f32 v208, v151, v155
  s_waitcnt lgkmcnt(3)
  v_mfma_f32_16x16x32_bf16 v[164:167], a[198:201], v[84:87], v[164:167]
  v_mfma_f32_16x16x32_bf16 v[168:171], a[196:199], v[84:87], v[168:171]
  s_waitcnt lgkmcnt(2)
  v_mfma_f32_16x16x32_bf16 v[172:175], a[198:201], v[88:91], v[172:175]
  v_mul_f32 v156, v192, v156
  v_mul_f32 v157, v193, v157
  v_mul_f32 v158, v194, v158
  v_mfma_f32_16x16x32_bf16 v[176:179], a[196:199], v[88:91], v[176:179]
  v_mul_f32 v159, v195, v159
  v_mul_f32 v160, v192, v160
  v_mul_f32 v161, v193, v161
  s_waitcnt lgkmcnt(1)
  v_mfma_f32_16x16x32_bf16 v[172:175], a[198:201], v[92:95], v[172:175]
  v_mul_f32 v162, v194, v162
  v_mul_f32 v163, v195, v163
  v_cvt_pk_bf16_f32 v197, v156, v160
  v_mfma_f32_16x16x32_bf16 v[176:179], a[196:199], v[92:95], v[176:179]
  buffer_store_dwordx2 v[196:197], v240, s[44:47], 0 offen offset:0 sc0 sc1
  v_cvt_pk_bf16_f32 v201, v157, v161
  buffer_store_dwordx2 v[200:201], v240, s[44:47], 0 offen offset:256 sc0 sc1
  s_waitcnt lgkmcnt(0)
  v_mfma_f32_16x16x32_bf16 v[172:175], a[198:201], v[96:99], v[172:175]
  v_cvt_pk_bf16_f32 v205, v158, v162
  buffer_store_dwordx2 v[204:205], v240, s[44:47], 0 offen offset:512 sc0 sc1
  v_cvt_pk_bf16_f32 v209, v159, v163
  v_mfma_f32_16x16x32_bf16 v[176:179], a[196:199], v[96:99], v[176:179]
  buffer_store_dwordx2 v[208:209], v240, s[44:47], 0 offen offset:768 sc0 sc1
  v_pk_mul_f32 v[164:165], v[164:165], v[192:193]
  v_pk_mul_f32 v[166:167], v[166:167], v[194:195]
  v_pk_mul_f32 v[168:169], v[168:169], v[192:193]
  v_pk_mul_f32 v[170:171], v[170:171], v[194:195]
  v_cvt_pk_bf16_f32 v198, v164, v168
  v_cvt_pk_bf16_f32 v202, v165, v169
  v_cvt_pk_bf16_f32 v206, v166, v170
  v_cvt_pk_bf16_f32 v210, v167, v171
  v_pk_mul_f32 v[172:173], v[172:173], v[192:193]
  v_pk_mul_f32 v[174:175], v[174:175], v[194:195]
  v_pk_mul_f32 v[176:177], v[176:177], v[192:193]
  v_pk_mul_f32 v[178:179], v[178:179], v[194:195]
  v_cvt_pk_bf16_f32 v199, v172, v176
  buffer_store_dwordx2 v[198:199], v240, s[44:47], 0 offen offset:128 sc0 sc1
  v_cvt_pk_bf16_f32 v203, v173, v177
  buffer_store_dwordx2 v[202:203], v240, s[44:47], 0 offen offset:384 sc0 sc1
  v_cvt_pk_bf16_f32 v207, v174, v178
  buffer_store_dwordx2 v[206:207], v240, s[44:47], 0 offen offset:640 sc0 sc1
  v_cvt_pk_bf16_f32 v211, v175, v179
  buffer_store_dwordx2 v[210:211], v240, s[44:47], 0 offen offset:896 sc0 sc1
M_end:
  s_endpgm
M_late1:
  s_waitcnt vmcnt(2)
  global_load_dwordx2 v[0:1], v255, s[32:33] sc1
  v_cvt_f32_i32 v208, v208
  v_cvt_f32_i32 v209, v209
  v_cvt_f32_i32 v210, v210
  v_cvt_f32_i32 v211, v211
  v_subrev_f32_dpp v208, v189, v208 row_newbcast:8 row_mask:0xf bank_mask:0xf
  v_subrev_f32_dpp v209, v189, v209 row_newbcast:8 row_mask:0xf bank_mask:0xf
  v_subrev_f32_dpp v210, v189, v210 row_newbcast:9 row_mask:0xf bank_mask:0xf
  v_subrev_f32_dpp v211, v189, v211 row_newbcast:9 row_mask:0xf bank_mask:0xf
  v_mul_f32_dpp v208, v188, v208 row_newbcast:8 row_mask:0xf bank_mask:0xf
  v_mul_f32_dpp v209, v188, v209 row_newbcast:8 row_mask:0xf bank_mask:0xf
  v_mul_f32_dpp v210, v188, v210 row_newbcast:9 row_mask:0xf bank_mask:0xf
  v_mul_f32_dpp v211, v188, v211 row_newbcast:9 row_mask:0xf bank_mask:0xf
  v_cvt_pk_bf16_f32 v224, v208, v210
  v_cvt_pk_bf16_f32 v228, v209, v211
  v_cvt_f32_i32 v212, v212
  v_cvt_f32_i32 v213, v213
  v_cvt_f32_i32 v214, v214
  v_cvt_f32_i32 v215, v215
  v_subrev_f32_dpp v212, v189, v212 row_newbcast:10 row_mask:0xf bank_mask:0xf
  v_subrev_f32_dpp v213, v189, v213 row_newbcast:10 row_mask:0xf bank_mask:0xf
  v_subrev_f32_dpp v214, v189, v214 row_newbcast:11 row_mask:0xf bank_mask:0xf
  v_subrev_f32_dpp v215, v189, v215 row_newbcast:11 row_mask:0xf bank_mask:0xf
  v_mul_f32_dpp v212, v188, v212 row_newbcast:10 row_mask:0xf bank_mask:0xf
  v_mul_f32_dpp v213, v188, v213 row_newbcast:10 row_mask:0xf bank_mask:0xf
  v_mul_f32_dpp v214, v188, v214 row_newbcast:11 row_mask:0xf bank_mask:0xf
  v_mul_f32_dpp v215, v188, v215 row_newbcast:11 row_mask:0xf bank_mask:0xf
  v_cvt_pk_bf16_f32 v225, v212, v214
  v_cvt_pk_bf16_f32 v229, v213, v215
  v_cvt_f32_i32 v216, v216
  v_cvt_f32_i32 v217, v217
  v_cvt_f32_i32 v218, v218
  v_cvt_f32_i32 v219, v219
  v_subrev_f32_dpp v216, v189, v216 row_newbcast:12 row_mask:0xf bank_mask:0xf
  v_subrev_f32_dpp v217, v189, v217 row_newbcast:12 row_mask:0xf bank_mask:0xf
  v_subrev_f32_dpp v218, v189, v218 row_newbcast:13 row_mask:0xf bank_mask:0xf
  v_subrev_f32_dpp v219, v189, v219 row_newbcast:13 row_mask:0xf bank_mask:0xf
  v_mul_f32_dpp v216, v188, v216 row_newbcast:12 row_mask:0xf bank_mask:0xf
  v_mul_f32_dpp v217, v188, v217 row_newbcast:12 row_mask:0xf bank_mask:0xf
  v_mul_f32_dpp v218, v188, v218 row_newbcast:13 row_mask:0xf bank_mask:0xf
  v_mul_f32_dpp v219, v188, v219 row_newbcast:13 row_mask:0xf bank_mask:0xf
  v_cvt_pk_bf16_f32 v226, v216, v218
  v_cvt_pk_bf16_f32 v230, v217, v219
  s_add_u32 s55, s55, 1
  s_waitcnt vmcnt(0)
  v_readfirstlane_b32 s58, v0
  v_readfirstlane_b32 s59, v1
  s_nop 2
  s_xor_b32 s58, s58, s36
  s_xor_b32 s59, s59, s36
  s_or_b32 s58, s58, s59
  s_and_b32 s58, s58, 0x9f9f9f9f
  s_cbranch_scc1 M_slow0
M_late3:
  buffer_load_dwordx4 a[0:3], v8, s[40:43], s48 offen offset:0 sc1
  buffer_load_dwordx4 a[4:7], v8, s[40:43], s48 offen offset:1024 sc1
  buffer_load_dwordx4 a[8:11], v8, s[40:43], s48 offen offset:2048 sc1
  buffer_load_dwordx4 a[12:15], v8, s[40:43], s48 offen offset:3072 sc1
  buffer_load_dwordx4 a[16:19], v9, s[40:43], s48 offen offset:0 sc1
  buffer_load_dwordx4 a[20:23], v9, s[40:43], s48 offen offset:1024 sc1
  buffer_load_dwordx4 a[24:27], v9, s[40:43], s48 offen offset:2048 sc1
  buffer_load_dwordx4 a[28:31], v9, s[40:43], s48 offen offset:3072 sc1
  buffer_load_dwordx4 a[32:35], v10, s[40:43], s48 offen offset:0 sc1
  buffer_load_dwordx4 a[36:39], v10, s[40:43], s48 offen offset:1024 sc1
  buffer_load_dwordx4 a[40:43], v10, s[40:43], s48 offen offset:2048 sc1
  buffer_load_dwordx4 a[44:47], v10, s[40:43], s48 offen offset:3072 sc1
  buffer_load_dwordx4 a[48:51], v11, s[40:43], s48 offen offset:0 sc1
  buffer_load_dwordx4 a[52:55], v11, s[40:43], s48 offen offset:1024 sc1
  buffer_load_dwordx4 a[56:59], v11, s[40:43], s48 offen offset:2048 sc1
  buffer_load_dwordx4 a[60:63], v11, s[40:43], s48 offen offset:3072 sc1
  s_add_u32 s48, s48, 0x4000
  buffer_load_dwordx4 a[64:67], v8, s[40:43], s48 offen offset:0 sc1
  buffer_load_dwordx4 a[68:71], v8, s[40:43], s48 offen offset:1024 sc1
  v_cvt_f32_i32 v220, v220
  v_cvt_f32_i32 v221, v221
  v_cvt_f32_i32 v222, v222
  v_cvt_f32_i32 v223, v223
  v_subrev_f32_dpp v220, v189, v220 row_newbcast:14 row_mask:0xf bank_mask:0xf
  v_subrev_f32_dpp v221, v189, v221 row_newbcast:14 row_mask:0xf bank_mask:0xf
  v_subrev_f32_dpp v222, v189, v222 row_newbcast:15 row_mask:0xf bank_mask:0xf
  v_subrev_f32_dpp v223, v189, v223 row_newbcast:15 row_mask:0xf bank_mask:0xf
  v_mul_f32_dpp v220, v188, v220 row_newbcast:14 row_mask:0xf bank_mask:0xf
  v_mul_f32_dpp v221, v188, v221 row_newbcast:14 row_mask:0xf bank_mask:0xf
  v_mul_f32_dpp v222, v188, v222 row_newbcast:15 row_mask:0xf bank_mask:0xf
  v_mul_f32_dpp v223, v188, v223 row_newbcast:15 row_mask:0xf bank_mask:0xf
  v_cvt_pk_bf16_f32 v227, v220, v222
  v_cvt_pk_bf16_f32 v231, v221, v223
  s_branch M_k0
M_slow0:
  s_sleep 1
  global_load_dwordx2 v[0:1], v255, s[32:33] sc1
  s_add_u32 s55, s55, 1
  s_waitcnt vmcnt(0)
  v_readfirstlane_b32 s58, v0
  v_readfirstlane_b32 s59, v1
  s_nop 2
  s_xor_b32 s58, s58, s36
  s_xor_b32 s59, s59, s36
  s_or_b32 s58, s58, s59
  s_and_b32 s58, s58, 0x9f9f9f9f
  s_cbranch_scc0 M_late3
  s_cmp_lt_u32 s55, 400
  s_cbranch_scc1 M_slow0
  s_branch M_self_a
M_slow1:
  s_sleep 1
  global_load_dwordx2 v[0:1], v255, s[32:33] sc1
  s_add_u32 s55, s55, 1
  s_waitcnt vmcnt(0)
  v_readfirstlane_b32 s58, v0
  v_readfirstlane_b32 s59, v1
  s_nop 2
  s_xor_b32 s58, s58, s36
  s_xor_b32 s59, s59, s36
  s_or_b32 s58, s58, s59
  s_and_b32 s58, s58, 0xbfbfbfbf
  s_cbranch_scc0 M_loop
  s_cmp_lt_u32 s55, 400
  s_cbranch_scc1 M_slow1
  s_branch M_self
M_slow2:
  s_sleep 1
  global_load_dwordx2 v[0:1], v255, s[32:33] sc1
  s_add_u32 s55, s55, 1
  s_waitcnt vmcnt(0)
  v_readfirstlane_b32 s58, v0
  v_readfirstlane_b32 s59, v1
  s_nop 2
  s_xor_b32 s58, s58, s36
  s_xor_b32 s59, s59, s36
  s_or_b32 s58, s58, s59
  s_cbranch_scc0 M_loop
  s_cmp_lt_u32 s55, 400
  s_cbranch_scc1 M_slow2
  s_branch M_self
M_codeend:
M_vote:
  ds_write_b32 v242, v243 offset:12
  s_branch M_voted
M_self_a:
  v_cvt_f32_i32 v220, v220
  v_cvt_f32_i32 v221, v221
  v_cvt_f32_i32 v222, v222
  v_cvt_f32_i32 v223, v223
  v_subrev_f32_dpp v220, v189, v220 row_newbcast:14 row_mask:0xf bank_mask:0xf
  v_subrev_f32_dpp v221, v189, v221 row_newbcast:14 row_mask:0xf bank_mask:0xf
  v_subrev_f32_dpp v222, v189, v222 row_newbcast:15 row_mask:0xf bank_mask:0xf
  v_subrev_f32_dpp v223, v189, v223 row_newbcast:15 row_mask:0xf bank_mask:0xf
  v_mul_f32_dpp v220, v188, v220 row_newbcast:14 row_mask:0xf bank_mask:0xf
  v_mul_f32_dpp v221, v188, v221 row_newbcast:14 row_mask:0xf bank_mask:0xf
  v_mul_f32_dpp v222, v188, v222 row_newbcast:15 row_mask:0xf bank_mask:0xf
  v_mul_f32_dpp v223, v188, v223 row_newbcast:15 row_mask:0xf bank_mask:0xf
  v_cvt_pk_bf16_f32 v227, v220, v222
  v_cvt_pk_bf16_f32 v231, v221, v223
  global_store_dwordx4 v190, v[192:195], s[34:35] offset:-4096 sc0 sc1
  global_store_dwordx4 v190, v[196:199], s[34:35] offset:0 sc0 sc1
  global_store_dwordx4 v191, v[224:227], s[34:35] offset:0 sc0 sc1
  global_store_dwordx4 v191, v[228:231], s[34:35] offset:1024 sc0 sc1
  s_waitcnt vmcnt(0) lgkmcnt(0)
  s_mov_b64 exec, 1
  ds_add_rtn_u32 v6, v242, v243 offset:8
  s_and_b32 s59, s36, 0x7f
  s_waitcnt lgkmcnt(0)
  v_readfirstlane_b32 s58, v6
  v_mov_b32 v6, s59
  s_nop 2
  s_cmp_eq_u32 s58, 3
  s_cbranch_scc0 M_pub2s
  global_store_byte v5, v6, s[32:33]
M_pub2s:
  s_mov_b64 exec, -1
M_self:
  s_waitcnt vmcnt(0) lgkmcnt(0)
  s_mov_b32 s60, 0
M_selfloop:
  s_lshr_b32 s6, s60, 2
  s_lshl_b32 s56, s3, 3
  s_add_u32 s6, s6, s56
  s_and_b32 s7, s60, 3
  s_xor_b32 s54, s7, 2
  s_lshl_b32 s56, s6, 6
  s_lshl_b32 s57, s54, 3
  s_add_u32 s61, s56, s57
  s_lshl_b32 s57, s7, 3
  s_add_u32 s56, s56, s57
  s_lshl_b32 s57, s38, 11
  s_add_u32 s56, s56, s57
  s_add_u32 s57, s57, s61
  s_lshl_b32 s58, s56, 9
  v_lshl_add_u32 v12, v2, 3, s58
  v_add_u32 v13, 16384, v12
  v_lshlrev_b32 v0, 8, v4
  v_lshl_add_u32 v0, v3, 3, v0
  s_lshl_b32 s58, s57, 8
  v_add_u32 v20, s58, v0
  v_add_u32 v21, 8192, v20
  v_lshlrev_b32 v14, 1, v20
  v_lshlrev_b32 v15, 1, v21
  s_lshl_b32 s58, s56, 3
  v_lshrrev_b32 v0, 3, v3
  v_lshl_add_u32 v18, v0, 8, s58
  v_and_b32 v1, 7, v3
  v_lshl_add_u32 v18, v1, 3, v18
  v_lshl_add_u32 v18, v4, 1, v18
  s_lshl_b32 s58, s57, 3
  v_lshl_add_u32 v19, v0, 1, s58
  v_lshl_add_u32 v19, v4, 3, v19
  v_bfe_u32 v1, v3, 2, 1
  v_lshl_add_u32 v19, v1, 8, v19
  v_bfe_u32 v1, v3, 1, 1
  v_lshl_add_u32 v19, v1, 5, v19
  v_and_b32 v1, 1, v3
  v_lshl_add_u32 v19, v1, 2, v19
  v_mov_b32 v188, 0
  v_mov_b32 v189, 0
  v_mov_b32 v190, 0
  v_mov_b32 v191, 0
  global_load_short_d16_hi v188, v18, s[18:19]
  global_load_short_d16_hi v189, v18, s[20:21]
  global_load_short_d16_hi v190, v19, s[12:13]
  global_load_short_d16_hi v191, v19, s[14:15]
  global_load_dwordx2 v[52:53], v12, s[16:17] offset:0
  global_load_dwordx2 v[54:55], v12, s[16:17] offset:512
  global_load_dwordx2 v[56:57], v12, s[16:17] offset:1024
  global_load_dwordx2 v[58:59], v12, s[16:17] offset:1536
  global_load_dwordx2 v[60:61], v12, s[16:17] offset:2048
  global_load_dwordx2 v[62:63], v12, s[16:17] offset:2560
  global_load_dwordx2 v[64:65], v12, s[16:17] offset:3072
  global_load_dwordx2 v[66:67], v12, s[16:17] offset:3584
  global_load_dwordx2 v[208:209], v13, s[16:17] offset:0
  global_load_dwordx2 v[210:211], v13, s[16:17] offset:512
  global_load_dwordx2 v[212:213], v13, s[16:17] offset:1024
  global_load_dwordx2 v[214:215], v13, s[16:17] offset:1536
  global_load_dwordx2 v[216:217], v13, s[16:17] offset:2048
  global_load_dwordx2 v[218:219], v13, s[16:17] offset:2560
  global_load_dwordx2 v[220:221], v13, s[16:17] offset:3072
  global_load_dwordx2 v[222:223], v13, s[16:17] offset:3584
  global_load_dwordx4 v[76:79], v14, s[10:11] offset:0
  global_load_dwordx4 v[80:83], v14, s[10:11] offset:256
  global_load_dwordx4 v[84:87], v14, s[10:11] offset:2048
  global_load_dwordx4 v[88:91], v14, s[10:11] offset:2304
  global_load_dwordx4 v[92:95], v15, s[10:11] offset:0
  global_load_dwordx4 v[96:99], v15, s[10:11] offset:256
  global_load_dwordx4 v[100:103], v15, s[10:11] offset:2048
  global_load_dwordx4 v[104:107], v15, s[10:11] offset:2304
  v_lshlrev_b32 v0, 2, v3
  v_cvt_f32_u32 v0, v0
  s_mov_b32 s59, 0xbe549a78
  v_mul_f32 v108, s59, v0
  v_add_f32 v1, 1.0, v0
  v_mul_f32 v109, s59, v1
  v_add_f32 v1, 2.0, v0
  v_mul_f32 v110, s59, v1
  v_add_f32 v1, 0x40400000, v0
  v_mul_f32 v111, s59, v1
  v_exp_f32 v108, v108
  v_exp_f32 v109, v109
  v_exp_f32 v110, v110
  v_exp_f32 v111, v111
  v_add_u32 v0, s61, v4
  v_add_u32 v1, 0, v0
  v_cvt_f32_u32 v1, v1
  v_mul_f32 v156, v1, v108
  v_mul_f32 v157, v1, v109
  v_mul_f32 v158, v1, v110
  v_mul_f32 v159, v1, v111
  v_mul_f32 v156, 0.15915494, v156
  v_mul_f32 v157, 0.15915494, v157
  v_mul_f32 v158, 0.15915494, v158
  v_mul_f32 v159, 0.15915494, v159
  v_fract_f32 v156, v156
  v_fract_f32 v157, v157
  v_fract_f32 v158, v158
  v_fract_f32 v159, v159
  v_sin_f32 v160, v156
  v_sin_f32 v161, v157
  v_sin_f32 v162, v158
  v_sin_f32 v163, v159
  v_cos_f32 v156, v156
  v_cos_f32 v157, v157
  v_cos_f32 v158, v158
  v_cos_f32 v159, v159
  v_cvt_pk_bf16_f32 v34, v160, v161
  v_cvt_pk_bf16_f32 v35, v162, v163
  v_cvt_pk_bf16_f32 v32, v156, v157
  v_cvt_pk_bf16_f32 v33, v158, v159
  v_lshlrev_b32 v156, 16, v32
  v_and_b32 v157, 0xffff0000, v32
  v_lshlrev_b32 v158, 16, v33
  v_and_b32 v159, 0xffff0000, v33
  v_lshlrev_b32 v160, 16, v34
  v_and_b32 v161, 0xffff0000, v34
  v_lshlrev_b32 v162, 16, v35
  v_and_b32 v163, 0xffff0000, v35
  v_add_u32 v1, 4, v0
  v_cvt_f32_u32 v1, v1
  v_mul_f32 v164, v1, v108
  v_mul_f32 v165, v1, v109
  v_mul_f32 v166, v1, v110
  v_mul_f32 v167, v1, v111
  v_mul_f32 v164, 0.15915494, v164
  v_mul_f32 v165, 0.15915494, v165
  v_mul_f32 v166, 0.15915494, v166
  v_mul_f32 v167, 0.15915494, v167
  v_fract_f32 v164, v164
  v_fract_f32 v165, v165
  v_fract_f32 v166, v166
  v_fract_f32 v167, v167
  v_sin_f32 v168, v164
  v_sin_f32 v169, v165
  v_sin_f32 v170, v166
  v_sin_f32 v171, v167
  v_cos_f32 v164, v164
  v_cos_f32 v165, v165
  v_cos_f32 v166, v166
  v_cos_f32 v167, v167
  v_cvt_pk_bf16_f32 v34, v168, v169
  v_cvt_pk_bf16_f32 v35, v170, v171
  v_cvt_pk_bf16_f32 v32, v164, v165
  v_cvt_pk_bf16_f32 v33, v166, v167
  v_lshlrev_b32 v164, 16, v32
  v_and_b32 v165, 0xffff0000, v32
  v_lshlrev_b32 v166, 16, v33
  v_and_b32 v167, 0xffff0000, v33
  v_lshlrev_b32 v168, 16, v34
  v_and_b32 v169, 0xffff0000, v34
  v_lshlrev_b32 v170, 16, v35
  v_and_b32 v171, 0xffff0000, v35
  v_add_u32 v1, 32, v0
  v_cvt_f32_u32 v1, v1
  v_mul_f32 v172, v1, v108
  v_mul_f32 v173, v1, v109
  v_mul_f32 v174, v1, v110
  v_mul_f32 v175, v1, v111
  v_mul_f32 v172, 0.15915494, v172
  v_mul_f32 v173, 0.15915494, v173
  v_mul_f32 v174, 0.15915494, v174
  v_mul_f32 v175, 0.15915494, v175
  v_fract_f32 v172, v172
  v_fract_f32 v173, v173
  v_fract_f32 v174, v174
  v_fract_f32 v175, v175
  v_sin_f32 v176, v172
  v_sin_f32 v177, v173
  v_sin_f32 v178, v174
  v_sin_f32 v179, v175
  v_cos_f32 v172, v172
  v_cos_f32 v173, v173
  v_cos_f32 v174, v174
  v_cos_f32 v175, v175
  v_cvt_pk_bf16_f32 v34, v176, v177
  v_cvt_pk_bf16_f32 v35, v178, v179
  v_cvt_pk_bf16_f32 v32, v172, v173
  v_cvt_pk_bf16_f32 v33, v174, v175
  v_lshlrev_b32 v172, 16, v32
  v_and_b32 v173, 0xffff0000, v32
  v_lshlrev_b32 v174, 16, v33
  v_and_b32 v175, 0xffff0000, v33
  v_lshlrev_b32 v176, 16, v34
  v_and_b32 v177, 0xffff0000, v34
  v_lshlrev_b32 v178, 16, v35
  v_and_b32 v179, 0xffff0000, v35
  v_add_u32 v1, 36, v0
  v_cvt_f32_u32 v1, v1
  v_mul_f32 v180, v1, v108
  v_mul_f32 v181, v1, v109
  v_mul_f32 v182, v1, v110
  v_mul_f32 v183, v1, v111
  v_mul_f32 v180, 0.15915494, v180
  v_mul_f32 v181, 0.15915494, v181
  v_mul_f32 v182, 0.15915494, v182
  v_mul_f32 v183, 0.15915494, v183
  v_fract_f32 v180, v180
  v_fract_f32 v181, v181
  v_fract_f32 v182, v182
  v_fract_f32 v183, v183
  v_sin_f32 v184, v180
  v_sin_f32 v185, v181
  v_sin_f32 v186, v182
  v_sin_f32 v187, v183
  v_cos_f32 v180, v180
  v_cos_f32 v181, v181
  v_cos_f32 v182, v182
  v_cos_f32 v183, v183
  v_cvt_pk_bf16_f32 v34, v184, v185
  v_cvt_pk_bf16_f32 v35, v186, v187
  v_cvt_pk_bf16_f32 v32, v180, v181
  v_cvt_pk_bf16_f32 v33, v182, v183
  v_lshlrev_b32 v180, 16, v32
  v_and_b32 v181, 0xffff0000, v32
  v_lshlrev_b32 v182, 16, v33
  v_and_b32 v183, 0xffff0000, v33
  v_lshlrev_b32 v184, 16, v34
  v_and_b32 v185, 0xffff0000, v34
  v_lshlrev_b32 v186, 16, v35
  v_and_b32 v187, 0xffff0000, v35
  s_lshr_b32 s56, s6, 3
  s_lshl_b32 s56, s56, 18
  s_lshl_b32 s57, s38, 20
  s_add_u32 s56, s56, s57
  s_bfe_u32 s57, s6, 0x20001
  s_lshl_b32 s57, s57, 14
  s_add_u32 s56, s56, s57
  s_and_b32 s57, s6, 1
  s_lshl_b32 s57, s57, 9
  s_add_u32 s56, s56, s57
  s_and_b32 s57, s7, 1
  s_lshl_b32 s57, s57, 8
  s_add_u32 s56, s56, s57
  s_lshr_b32 s57, s54, 1
  s_lshl_b32 s57, s57, 16
  s_lshr_b32 s58, s7, 1
  s_lshl_b32 s58, s58, 16
  s_add_u32 s57, s57, s56
  s_add_u32 s57, s57, 4096
  s_add_u32 s58, s58, s56
  s_add_u32 s58, s58, 8192
  v_lshrrev_b32 v0, 2, v3
  v_lshl_add_u32 v22, v0, 10, s57
  v_and_b32 v0, 3, v3
  v_lshl_add_u32 v22, v0, 6, v22
  v_lshl_add_u32 v22, v4, 4, v22
  v_lshrrev_b32 v0, 5, v2
  v_lshl_add_u32 v23, v0, 12, s58
  v_and_b32 v0, 1, v2
  v_lshl_add_u32 v23, v0, 11, v23
  v_bfe_u32 v0, v2, 1, 4
  v_lshl_add_u32 v23, v0, 4, v23
  s_waitcnt vmcnt(0)
  v_mul_f32 v190, 0x3e0293ee, v190
  v_mul_f32 v191, v191, v190
  ds_swizzle_b32 v192, v190 offset:swizzle(BROADCAST,8,0)
  ds_swizzle_b32 v193, v191 offset:swizzle(BROADCAST,8,0)
  ds_swizzle_b32 v194, v190 offset:swizzle(BROADCAST,8,1)
  ds_swizzle_b32 v195, v191 offset:swizzle(BROADCAST,8,1)
  ds_swizzle_b32 v196, v190 offset:swizzle(BROADCAST,8,2)
  ds_swizzle_b32 v197, v191 offset:swizzle(BROADCAST,8,2)
  ds_swizzle_b32 v198, v190 offset:swizzle(BROADCAST,8,3)
  ds_swizzle_b32 v199, v191 offset:swizzle(BROADCAST,8,3)
  ds_swizzle_b32 v200, v190 offset:swizzle(BROADCAST,8,4)
  ds_swizzle_b32 v201, v191 offset:swizzle(BROADCAST,8,4)
  ds_swizzle_b32 v202, v190 offset:swizzle(BROADCAST,8,5)
  ds_swizzle_b32 v203, v191 offset:swizzle(BROADCAST,8,5)
  ds_swizzle_b32 v204, v190 offset:swizzle(BROADCAST,8,6)
  ds_swizzle_b32 v205, v191 offset:swizzle(BROADCAST,8,6)
  ds_swizzle_b32 v206, v190 offset:swizzle(BROADCAST,8,7)
  ds_swizzle_b32 v207, v191 offset:swizzle(BROADCAST,8,7)
  s_waitcnt lgkmcnt(0)
  s_lshr_b32 s56, s6, 3
  s_lshl_b32 s56, s56, 18
  s_lshl_b32 s57, s38, 20
  s_add_u32 s56, s56, s57
  s_and_b32 s57, s6, 7
  s_lshl_b32 s57, s57, 14
  s_add_u32 s56, s56, s57
  s_add_u32 s56, s56, 0x20000
  s_lshl_b32 s57, s54, 8
  s_lshl_b32 s58, s7, 8
  s_add_u32 s57, s57, s56
  s_add_u32 s57, s57, 4096
  s_add_u32 s58, s58, s56
  s_add_u32 s58, s58, 8192
  v_lshrrev_b32 v0, 2, v3
  v_lshl_add_u32 v190, v0, 10, s57
  v_and_b32 v0, 3, v3
  v_lshl_add_u32 v190, v0, 6, v190
  v_lshl_add_u32 v190, v4, 4, v190
  v_lshrrev_b32 v0, 5, v2
  v_lshl_add_u32 v191, v0, 12, s58
  v_and_b32 v0, 1, v2
  v_lshl_add_u32 v191, v0, 11, v191
  v_bfe_u32 v0, v2, 1, 4
  v_lshl_add_u32 v191, v0, 4, v191
  v_cvt_f32_i32 v52, v52
  v_cvt_f32_i32 v53, v53
  v_cvt_f32_i32 v54, v54
  v_cvt_f32_i32 v55, v55
  v_subrev_f32_dpp v52, v189, v52 row_newbcast:0 row_mask:0xf bank_mask:0xf
  v_subrev_f32_dpp v53, v189, v53 row_newbcast:0 row_mask:0xf bank_mask:0xf
  v_subrev_f32_dpp v54, v189, v54 row_newbcast:1 row_mask:0xf bank_mask:0xf
  v_subrev_f32_dpp v55, v189, v55 row_newbcast:1 row_mask:0xf bank_mask:0xf
  v_mul_f32_dpp v52, v188, v52 row_newbcast:0 row_mask:0xf bank_mask:0xf
  v_mul_f32_dpp v53, v188, v53 row_newbcast:0 row_mask:0xf bank_mask:0xf
  v_mul_f32_dpp v54, v188, v54 row_newbcast:1 row_mask:0xf bank_mask:0xf
  v_mul_f32_dpp v55, v188, v55 row_newbcast:1 row_mask:0xf bank_mask:0xf
  v_cvt_pk_bf16_f32 v68, v52, v54
  v_cvt_pk_bf16_f32 v72, v53, v55
  v_cvt_f32_i32 v56, v56
  v_cvt_f32_i32 v57, v57
  v_cvt_f32_i32 v58, v58
  v_cvt_f32_i32 v59, v59
  v_subrev_f32_dpp v56, v189, v56 row_newbcast:2 row_mask:0xf bank_mask:0xf
  v_subrev_f32_dpp v57, v189, v57 row_newbcast:2 row_mask:0xf bank_mask:0xf
  v_subrev_f32_dpp v58, v189, v58 row_newbcast:3 row_mask:0xf bank_mask:0xf
  v_subrev_f32_dpp v59, v189, v59 row_newbcast:3 row_mask:0xf bank_mask:0xf
  v_mul_f32_dpp v56, v188, v56 row_newbcast:2 row_mask:0xf bank_mask:0xf
  v_mul_f32_dpp v57, v188, v57 row_newbcast:2 row_mask:0xf bank_mask:0xf
  v_mul_f32_dpp v58, v188, v58 row_newbcast:3 row_mask:0xf bank_mask:0xf
  v_mul_f32_dpp v59, v188, v59 row_newbcast:3 row_mask:0xf bank_mask:0xf
  v_cvt_pk_bf16_f32 v69, v56, v58
  v_cvt_pk_bf16_f32 v73, v57, v59
  v_cvt_f32_i32 v60, v60
  v_cvt_f32_i32 v61, v61
  v_cvt_f32_i32 v62, v62
  v_cvt_f32_i32 v63, v63
  v_subrev_f32_dpp v60, v189, v60 row_newbcast:4 row_mask:0xf bank_mask:0xf
  v_subrev_f32_dpp v61, v189, v61 row_newbcast:4 row_mask:0xf bank_mask:0xf
  v_subrev_f32_dpp v62, v189, v62 row_newbcast:5 row_mask:0xf bank_mask:0xf
  v_subrev_f32_dpp v63, v189, v63 row_newbcast:5 row_mask:0xf bank_mask:0xf
  v_mul_f32_dpp v60, v188, v60 row_newbcast:4 row_mask:0xf bank_mask:0xf
  v_mul_f32_dpp v61, v188, v61 row_newbcast:4 row_mask:0xf bank_mask:0xf
  v_mul_f32_dpp v62, v188, v62 row_newbcast:5 row_mask:0xf bank_mask:0xf
  v_mul_f32_dpp v63, v188, v63 row_newbcast:5 row_mask:0xf bank_mask:0xf
  v_cvt_pk_bf16_f32 v70, v60, v62
  v_cvt_pk_bf16_f32 v74, v61, v63
  v_cvt_f32_i32 v64, v64
  v_cvt_f32_i32 v65, v65
  v_cvt_f32_i32 v66, v66
  v_cvt_f32_i32 v67, v67
  v_subrev_f32_dpp v64, v189, v64 row_newbcast:6 row_mask:0xf bank_mask:0xf
  v_subrev_f32_dpp v65, v189, v65 row_newbcast:6 row_mask:0xf bank_mask:0xf
  v_subrev_f32_dpp v66, v189, v66 row_newbcast:7 row_mask:0xf bank_mask:0xf
  v_subrev_f32_dpp v67, v189, v67 row_newbcast:7 row_mask:0xf bank_mask:0xf
  v_mul_f32_dpp v64, v188, v64 row_newbcast:6 row_mask:0xf bank_mask:0xf
  v_mul_f32_dpp v65, v188, v65 row_newbcast:6 row_mask:0xf bank_mask:0xf
  v_mul_f32_dpp v66, v188, v66 row_newbcast:7 row_mask:0xf bank_mask:0xf
  v_mul_f32_dpp v67, v188, v67 row_newbcast:7 row_mask:0xf bank_mask:0xf
  v_cvt_pk_bf16_f32 v71, v64, v66
  v_cvt_pk_bf16_f32 v75, v65, v67
  global_store_dwordx4 v23, v[68:71], s[34:35] offset:0 sc0 sc1
  global_store_dwordx4 v23, v[72:75], s[34:35] offset:1024 sc0 sc1
  v_cvt_f32_i32 v208, v208
  v_cvt_f32_i32 v209, v209
  v_cvt_f32_i32 v210, v210
  v_cvt_f32_i32 v211, v211
  v_subrev_f32_dpp v208, v189, v208 row_newbcast:8 row_mask:0xf bank_mask:0xf
  v_subrev_f32_dpp v209, v189, v209 row_newbcast:8 row_mask:0xf bank_mask:0xf
  v_subrev_f32_dpp v210, v189, v210 row_newbcast:9 row_mask:0xf bank_mask:0xf
  v_subrev_f32_dpp v211, v189, v211 row_newbcast:9 row_mask:0xf bank_mask:0xf
  v_mul_f32_dpp v208, v188, v208 row_newbcast:8 row_mask:0xf bank_mask:0xf
  v_mul_f32_dpp v209, v188, v209 row_newbcast:8 row_mask:0xf bank_mask:0xf
  v_mul_f32_dpp v210, v188, v210 row_newbcast:9 row_mask:0xf bank_mask:0xf
  v_mul_f32_dpp v211, v188, v211 row_newbcast:9 row_mask:0xf bank_mask:0xf
  v_cvt_pk_bf16_f32 v224, v208, v210
  v_cvt_pk_bf16_f32 v228, v209, v211
  v_cvt_f32_i32 v212, v212
  v_cvt_f32_i32 v213, v213
  v_cvt_f32_i32 v214, v214
  v_cvt_f32_i32 v215, v215
  v_subrev_f32_dpp v212, v189, v212 row_newbcast:10 row_mask:0xf bank_mask:0xf
  v_subrev_f32_dpp v213, v189, v213 row_newbcast:10 row_mask:0xf bank_mask:0xf
  v_subrev_f32_dpp v214, v189, v214 row_newbcast:11 row_mask:0xf bank_mask:0xf
  v_subrev_f32_dpp v215, v189, v215 row_newbcast:11 row_mask:0xf bank_mask:0xf
  v_mul_f32_dpp v212, v188, v212 row_newbcast:10 row_mask:0xf bank_mask:0xf
  v_mul_f32_dpp v213, v188, v213 row_newbcast:10 row_mask:0xf bank_mask:0xf
  v_mul_f32_dpp v214, v188, v214 row_newbcast:11 row_mask:0xf bank_mask:0xf
  v_mul_f32_dpp v215, v188, v215 row_newbcast:11 row_mask:0xf bank_mask:0xf
  v_cvt_pk_bf16_f32 v225, v212, v214
  v_cvt_pk_bf16_f32 v229, v213, v215
  v_cvt_f32_i32 v216, v216
  v_cvt_f32_i32 v217, v217
  v_cvt_f32_i32 v218, v218
  v_cvt_f32_i32 v219, v219
  v_subrev_f32_dpp v216, v189, v216 row_newbcast:12 row_mask:0xf bank_mask:0xf
  v_subrev_f32_dpp v217, v189, v217 row_newbcast:12 row_mask:0xf bank_mask:0xf
  v_subrev_f32_dpp v218, v189, v218 row_newbcast:13 row_mask:0xf bank_mask:0xf
  v_subrev_f32_dpp v219, v189, v219 row_newbcast:13 row_mask:0xf bank_mask:0xf
  v_mul_f32_dpp v216, v188, v216 row_newbcast:12 row_mask:0xf bank_mask:0xf
  v_mul_f32_dpp v217, v188, v217 row_newbcast:12 row_mask:0xf bank_mask:0xf
  v_mul_f32_dpp v218, v188, v218 row_newbcast:13 row_mask:0xf bank_mask:0xf
  v_mul_f32_dpp v219, v188, v219 row_newbcast:13 row_mask:0xf bank_mask:0xf
  v_cvt_pk_bf16_f32 v226, v216, v218
  v_cvt_pk_bf16_f32 v230, v217, v219
  v_cvt_f32_i32 v220, v220
  v_cvt_f32_i32 v221, v221
  v_cvt_f32_i32 v222, v222
  v_cvt_f32_i32 v223, v223
  v_subrev_f32_dpp v220, v189, v220 row_newbcast:14 row_mask:0xf bank_mask:0xf
  v_subrev_f32_dpp v221, v189, v221 row_newbcast:14 row_mask:0xf bank_mask:0xf
  v_subrev_f32_dpp v222, v189, v222 row_newbcast:15 row_mask:0xf bank_mask:0xf
  v_subrev_f32_dpp v223, v189, v223 row_newbcast:15 row_mask:0xf bank_mask:0xf
  v_mul_f32_dpp v220, v188, v220 row_newbcast:14 row_mask:0xf bank_mask:0xf
  v_mul_f32_dpp v221, v188, v221 row_newbcast:14 row_mask:0xf bank_mask:0xf
  v_mul_f32_dpp v222, v188, v222 row_newbcast:15 row_mask:0xf bank_mask:0xf
  v_mul_f32_dpp v223, v188, v223 row_newbcast:15 row_mask:0xf bank_mask:0xf
  v_cvt_pk_bf16_f32 v227, v220, v222
  v_cvt_pk_bf16_f32 v231, v221, v223
  global_store_dwordx4 v191, v[224:227], s[34:35] offset:0 sc0 sc1
  global_store_dwordx4 v191, v[228:231], s[34:35] offset:1024 sc0 sc1
  v_cvt_f32_i32 v76, v76
  v_cvt_f32_i32 v77, v77
  v_cvt_f32_i32 v78, v78
  v_cvt_f32_i32 v79, v79
  v_cvt_f32_i32 v80, v80
  v_cvt_f32_i32 v81, v81
  v_cvt_f32_i32 v82, v82
  v_cvt_f32_i32 v83, v83
  v_pk_fma_f32 v[76:77], v[76:77], v[192:193], v[192:193] op_sel:[0,0,1] op_sel_hi:[1,0,1] neg_lo:[0,0,1] neg_hi:[0,0,1]
  v_pk_fma_f32 v[78:79], v[78:79], v[192:193], v[192:193] op_sel:[0,0,1] op_sel_hi:[1,0,1] neg_lo:[0,0,1] neg_hi:[0,0,1]
  v_pk_fma_f32 v[80:81], v[80:81], v[194:195], v[194:195] op_sel:[0,0,1] op_sel_hi:[1,0,1] neg_lo:[0,0,1] neg_hi:[0,0,1]
  v_pk_fma_f32 v[82:83], v[82:83], v[194:195], v[194:195] op_sel:[0,0,1] op_sel_hi:[1,0,1] neg_lo:[0,0,1] neg_hi:[0,0,1]
  v_pk_mul_f32 v[28:29], v[76:77], v[156:157]
  v_pk_mul_f32 v[32:33], v[80:81], v[156:157]
  v_pk_mul_f32 v[30:31], v[78:79], v[158:159]
  v_pk_mul_f32 v[34:35], v[82:83], v[158:159]
  v_pk_fma_f32 v[28:29], v[80:81], v[160:161], v[28:29] neg_lo:[1,0,0] neg_hi:[1,0,0]
  v_pk_fma_f32 v[32:33], v[76:77], v[160:161], v[32:33]
  v_pk_fma_f32 v[30:31], v[82:83], v[162:163], v[30:31] neg_lo:[1,0,0] neg_hi:[1,0,0]
  v_pk_fma_f32 v[34:35], v[78:79], v[162:163], v[34:35]
  v_cvt_pk_bf16_f32 v76, v28, v29
  v_cvt_pk_bf16_f32 v77, v30, v31
  v_cvt_pk_bf16_f32 v78, v32, v33
  v_cvt_pk_bf16_f32 v79, v34, v35
  global_store_dwordx4 v22, v[76:79], s[34:35] offset:-4096 sc0 sc1
  v_cvt_f32_i32 v84, v84
  v_cvt_f32_i32 v85, v85
  v_cvt_f32_i32 v86, v86
  v_cvt_f32_i32 v87, v87
  v_cvt_f32_i32 v88, v88
  v_cvt_f32_i32 v89, v89
  v_cvt_f32_i32 v90, v90
  v_cvt_f32_i32 v91, v91
  v_pk_fma_f32 v[84:85], v[84:85], v[196:197], v[196:197] op_sel:[0,0,1] op_sel_hi:[1,0,1] neg_lo:[0,0,1] neg_hi:[0,0,1]
  v_pk_fma_f32 v[86:87], v[86:87], v[196:197], v[196:197] op_sel:[0,0,1] op_sel_hi:[1,0,1] neg_lo:[0,0,1] neg_hi:[0,0,1]
  v_pk_fma_f32 v[88:89], v[88:89], v[198:199], v[198:199] op_sel:[0,0,1] op_sel_hi:[1,0,1] neg_lo:[0,0,1] neg_hi:[0,0,1]
  v_pk_fma_f32 v[90:91], v[90:91], v[198:199], v[198:199] op_sel:[0,0,1] op_sel_hi:[1,0,1] neg_lo:[0,0,1] neg_hi:[0,0,1]
  v_pk_mul_f32 v[28:29], v[84:85], v[164:165]
  v_pk_mul_f32 v[32:33], v[88:89], v[164:165]
  v_pk_mul_f32 v[30:31], v[86:87], v[166:167]
  v_pk_mul_f32 v[34:35], v[90:91], v[166:167]
  v_pk_fma_f32 v[28:29], v[88:89], v[168:169], v[28:29] neg_lo:[1,0,0] neg_hi:[1,0,0]
  v_pk_fma_f32 v[32:33], v[84:85], v[168:169], v[32:33]
  v_pk_fma_f32 v[30:31], v[90:91], v[170:171], v[30:31] neg_lo:[1,0,0] neg_hi:[1,0,0]
  v_pk_fma_f32 v[34:35], v[86:87], v[170:171], v[34:35]
  v_cvt_pk_bf16_f32 v84, v28, v29
  v_cvt_pk_bf16_f32 v85, v30, v31
  v_cvt_pk_bf16_f32 v86, v32, v33
  v_cvt_pk_bf16_f32 v87, v34, v35
  global_store_dwordx4 v22, v[84:87], s[34:35] offset:0 sc0 sc1
  v_cvt_f32_i32 v92, v92
  v_cvt_f32_i32 v93, v93
  v_cvt_f32_i32 v94, v94
  v_cvt_f32_i32 v95, v95
  v_cvt_f32_i32 v96, v96
  v_cvt_f32_i32 v97, v97
  v_cvt_f32_i32 v98, v98
  v_cvt_f32_i32 v99, v99
  v_pk_fma_f32 v[92:93], v[92:93], v[200:201], v[200:201] op_sel:[0,0,1] op_sel_hi:[1,0,1] neg_lo:[0,0,1] neg_hi:[0,0,1]
  v_pk_fma_f32 v[94:95], v[94:95], v[200:201], v[200:201] op_sel:[0,0,1] op_sel_hi:[1,0,1] neg_lo:[0,0,1] neg_hi:[0,0,1]
  v_pk_fma_f32 v[96:97], v[96:97], v[202:203], v[202:203] op_sel:[0,0,1] op_sel_hi:[1,0,1] neg_lo:[0,0,1] neg_hi:[0,0,1]
  v_pk_fma_f32 v[98:99], v[98:99], v[202:203], v[202:203] op_sel:[0,0,1] op_sel_hi:[1,0,1] neg_lo:[0,0,1] neg_hi:[0,0,1]
  v_pk_mul_f32 v[28:29], v[92:93], v[172:173]
  v_pk_mul_f32 v[32:33], v[96:97], v[172:173]
  v_pk_mul_f32 v[30:31], v[94:95], v[174:175]
  v_pk_mul_f32 v[34:35], v[98:99], v[174:175]
  v_pk_fma_f32 v[28:29], v[96:97], v[176:177], v[28:29] neg_lo:[1,0,0] neg_hi:[1,0,0]
  v_pk_fma_f32 v[32:33], v[92:93], v[176:177], v[32:33]
  v_pk_fma_f32 v[30:31], v[98:99], v[178:179], v[30:31] neg_lo:[1,0,0] neg_hi:[1,0,0]
  v_pk_fma_f32 v[34:35], v[94:95], v[178:179], v[34:35]
  v_cvt_pk_bf16_f32 v192, v28, v29
  v_cvt_pk_bf16_f32 v193, v30, v31
  v_cvt_pk_bf16_f32 v194, v32, v33
  v_cvt_pk_bf16_f32 v195, v34, v35
  global_store_dwordx4 v190, v[192:195], s[34:35] offset:-4096 sc0 sc1
  v_cvt_f32_i32 v100, v100
  v_cvt_f32_i32 v101, v101
  v_cvt_f32_i32 v102, v102
  v_cvt_f32_i32 v103, v103
  v_cvt_f32_i32 v104, v104
  v_cvt_f32_i32 v105, v105
  v_cvt_f32_i32 v106, v106
  v_cvt_f32_i32 v107, v107
  v_pk_fma_f32 v[100:101], v[100:101], v[204:205], v[204:205] op_sel:[0,0,1] op_sel_hi:[1,0,1] neg_lo:[0,0,1] neg_hi:[0,0,1]
  v_pk_fma_f32 v[102:103], v[102:103], v[204:205], v[204:205] op_sel:[0,0,1] op_sel_hi:[1,0,1] neg_lo:[0,0,1] neg_hi:[0,0,1]
  v_pk_fma_f32 v[104:105], v[104:105], v[206:207], v[206:207] op_sel:[0,0,1] op_sel_hi:[1,0,1] neg_lo:[0,0,1] neg_hi:[0,0,1]
  v_pk_fma_f32 v[106:107], v[106:107], v[206:207], v[206:207] op_sel:[0,0,1] op_sel_hi:[1,0,1] neg_lo:[0,0,1] neg_hi:[0,0,1]
  v_pk_mul_f32 v[28:29], v[100:101], v[180:181]
  v_pk_mul_f32 v[32:33], v[104:105], v[180:181]
  v_pk_mul_f32 v[30:31], v[102:103], v[182:183]
  v_pk_mul_f32 v[34:35], v[106:107], v[182:183]
  v_pk_fma_f32 v[28:29], v[104:105], v[184:185], v[28:29] neg_lo:[1,0,0] neg_hi:[1,0,0]
  v_pk_fma_f32 v[32:33], v[100:101], v[184:185], v[32:33]
  v_pk_fma_f32 v[30:31], v[106:107], v[186:187], v[30:31] neg_lo:[1,0,0] neg_hi:[1,0,0]
  v_pk_fma_f32 v[34:35], v[102:103], v[186:187], v[34:35]
  v_cvt_pk_bf16_f32 v196, v28, v29
  v_cvt_pk_bf16_f32 v197, v30, v31
  v_cvt_pk_bf16_f32 v198, v32, v33
  v_cvt_pk_bf16_f32 v199, v34, v35
  global_store_dwordx4 v190, v[196:199], s[34:35] offset:0 sc0 sc1
  s_waitcnt vmcnt(0)
  s_add_u32 s60, s60, 1
  s_cmp_lt_u32 s60, 32
  s_cbranch_scc1 M_selfloop
  s_branch M_restart
M_fallback:
  s_waitcnt vmcnt(0) lgkmcnt(0)
  s_mov_b32 s50, 1
  s_mov_b32 s48, 0
  v_mov_b32 v244, 0xff800000
  v_mov_b32 v245, 0xff800000
  v_mov_b32 v246, 0xff800000
  v_mov_b32 v247, 0xff800000
M_fbloop:
  buffer_load_dwordx4 a[0:3], v8, s[40:43], s48 offen offset:0 sc1
  buffer_load_dwordx4 a[4:7], v8, s[40:43], s48 offen offset:1024 sc1
  buffer_load_dwordx4 a[8:11], v8, s[40:43], s48 offen offset:2048 sc1
  buffer_load_dwordx4 a[12:15], v8, s[40:43], s48 offen offset:3072 sc1
  buffer_load_dwordx4 a[16:19], v9, s[40:43], s48 offen offset:0 sc1
  buffer_load_dwordx4 a[20:23], v9, s[40:43], s48 offen offset:1024 sc1
  buffer_load_dwordx4 a[24:27], v9, s[40:43], s48 offen offset:2048 sc1
  buffer_load_dwordx4 a[28:31], v9, s[40:43], s48 offen offset:3072 sc1
  s_waitcnt vmcnt(0)
  v_mfma_f32_16x16x32_bf16 v[12:15], a[0:3], a[128:131], 0
  v_mfma_f32_16x16x32_bf16 v[16:19], a[0:3], a[144:147], 0
  v_mfma_f32_16x16x32_bf16 v[20:23], a[0:3], a[160:163], 0
  v_mfma_f32_16x16x32_bf16 v[24:27], a[0:3], a[176:179], 0
  v_mfma_f32_16x16x32_bf16 v[12:15], a[4:7], a[132:135], v[12:15]
  v_mfma_f32_16x16x32_bf16 v[16:19], a[4:7], a[148:151], v[16:19]
  v_mfma_f32_16x16x32_bf16 v[20:23], a[4:7], a[164:167], v[20:23]
  v_mfma_f32_16x16x32_bf16 v[24:27], a[4:7], a[180:183], v[24:27]
  v_mfma_f32_16x16x32_bf16 v[12:15], a[8:11], a[136:139], v[12:15]
  v_mfma_f32_16x16x32_bf16 v[16:19], a[8:11], a[152:155], v[16:19]
  v_mfma_f32_16x16x32_bf16 v[20:23], a[8:11], a[168:171], v[20:23]
  v_mfma_f32_16x16x32_bf16 v[24:27], a[8:11], a[184:187], v[24:27]
  v_mfma_f32_16x16x32_bf16 v[12:15], a[12:15], a[140:143], v[12:15]
  v_mfma_f32_16x16x32_bf16 v[16:19], a[12:15], a[156:159], v[16:19]
  v_mfma_f32_16x16x32_bf16 v[20:23], a[12:15], a[172:175], v[20:23]
  v_mfma_f32_16x16x32_bf16 v[24:27], a[12:15], a[188:191], v[24:27]
  s_nop 7
  v_max3_f32 v244, v244, v12, v13
  v_max3_f32 v244, v244, v14, v15
  v_max3_f32 v245, v245, v16, v17
  v_max3_f32 v245, v245, v18, v19
  v_max3_f32 v246, v246, v20, v21
  v_max3_f32 v246, v246, v22, v23
  v_max3_f32 v247, v247, v24, v25
  v_max3_f32 v247, v247, v26, v27
  s_nop 1
  v_mfma_f32_16x16x32_bf16 v[12:15], a[16:19], a[128:131], 0
  v_mfma_f32_16x16x32_bf16 v[16:19], a[16:19], a[144:147], 0
  v_mfma_f32_16x16x32_bf16 v[20:23], a[16:19], a[160:163], 0
  v_mfma_f32_16x16x32_bf16 v[24:27], a[16:19], a[176:179], 0
  v_mfma_f32_16x16x32_bf16 v[12:15], a[20:23], a[132:135], v[12:15]
  v_mfma_f32_16x16x32_bf16 v[16:19], a[20:23], a[148:151], v[16:19]
  v_mfma_f32_16x16x32_bf16 v[20:23], a[20:23], a[164:167], v[20:23]
  v_mfma_f32_16x16x32_bf16 v[24:27], a[20:23], a[180:183], v[24:27]
  v_mfma_f32_16x16x32_bf16 v[12:15], a[24:27], a[136:139], v[12:15]
  v_mfma_f32_16x16x32_bf16 v[16:19], a[24:27], a[152:155], v[16:19]
  v_mfma_f32_16x16x32_bf16 v[20:23], a[24:27], a[168:171], v[20:23]
  v_mfma_f32_16x16x32_bf16 v[24:27], a[24:27], a[184:187], v[24:27]
  v_mfma_f32_16x16x32_bf16 v[12:15], a[28:31], a[140:143], v[12:15]
  v_mfma_f32_16x16x32_bf16 v[16:19], a[28:31], a[156:159], v[16:19]
  v_mfma_f32_16x16x32_bf16 v[20:23], a[28:31], a[172:175], v[20:23]
  v_mfma_f32_16x16x32_bf16 v[24:27], a[28:31], a[188:191], v[24:27]
  s_nop 7
  v_max3_f32 v244, v244, v12, v13
  v_max3_f32 v244, v244, v14, v15
  v_max3_f32 v245, v245, v16, v17
  v_max3_f32 v245, v245, v18, v19
  v_max3_f32 v246, v246, v20, v21
  v_max3_f32 v246, v246, v22, v23
  v_max3_f32 v247, v247, v24, v25
  v_max3_f32 v247, v247, v26, v27
  s_nop 1
  s_add_u32 s48, s48, 0x4000
  s_cmp_lt_u32 s48, 0x40000
  s_cbranch_scc1 M_fbloop
  s_lshl_b32 s58, s3, 8
  s_add_u32 s58, s58, 65536
  v_lshl_add_u32 v31, v2, 2, s58
  v_xor_b32 v28, 0x100, v31
  v_xor_b32 v29, 0x200, v31
  v_xor_b32 v30, 0x300, v31
  s_lshl_b32 s58, s3, 10
  v_add_u32 v32, s58, v28
  ds_write_b32 v32, v244
  v_add_u32 v33, s58, v29
  ds_write_b32 v33, v245
  v_add_u32 v34, s58, v30
  ds_write_b32 v34, v246
  v_add_u32 v35, s58, v31
  ds_write_b32 v35, v247
  s_waitcnt lgkmcnt(0)
  s_barrier
  ds_read_b32 v12, v28 offset:0
  ds_read_b32 v13, v28 offset:1024
  ds_read_b32 v14, v28 offset:2048
  ds_read_b32 v15, v28 offset:3072
  s_waitcnt lgkmcnt(0)
  v_max3_f32 v244, v12, v13, v14
  v_max_f32 v244, v244, v15
  ds_read_b32 v16, v29 offset:0
  ds_read_b32 v17, v29 offset:1024
  ds_read_b32 v18, v29 offset:2048
  ds_read_b32 v19, v29 offset:3072
  s_waitcnt lgkmcnt(0)
  v_max3_f32 v245, v16, v17, v18
  v_max_f32 v245, v245, v19
  ds_read_b32 v20, v30 offset:0
  ds_read_b32 v21, v30 offset:1024
  ds_read_b32 v22, v30 offset:2048
  ds_read_b32 v23, v30 offset:3072
  s_waitcnt lgkmcnt(0)
  v_max3_f32 v246, v20, v21, v22
  v_max_f32 v246, v246, v23
  ds_read_b32 v24, v31 offset:0
  ds_read_b32 v25, v31 offset:1024
  ds_read_b32 v26, v31 offset:2048
  ds_read_b32 v27, v31 offset:3072
  s_waitcnt lgkmcnt(0)
  v_max3_f32 v247, v24, v25, v26
  v_max_f32 v247, v247, v27
  v_mov_b32 v248, v244
  v_mov_b32 v249, v245
  v_mov_b32 v250, v246
  v_mov_b32 v251, v247
  s_nop 1
  v_permlane16_swap_b32 v244, v248
  v_permlane16_swap_b32 v245, v249
  v_permlane16_swap_b32 v246, v250
  v_permlane16_swap_b32 v247, v251
  s_nop 1
  v_max_f32 v244, v244, v248
  v_max_f32 v245, v245, v249
  v_max_f32 v246, v246, v250
  v_max_f32 v247, v247, v251
  v_mov_b32 v248, v244
  v_mov_b32 v249, v245
  v_mov_b32 v250, v246
  v_mov_b32 v251, v247
  s_nop 1
  v_permlane32_swap_b32 v244, v248
  v_permlane32_swap_b32 v245, v249
  v_permlane32_swap_b32 v246, v250
  v_permlane32_swap_b32 v247, v251
  s_nop 1
  v_max_f32 v244, v244, v248
  v_max_f32 v245, v245, v249
  v_max_f32 v246, v246, v250
  v_max_f32 v247, v247, v251
  v_xor_b32 v36, 0x80000000, v244
  v_xor_b32 v37, 0x80000000, v244
  v_xor_b32 v38, 0x80000000, v244
  v_xor_b32 v39, 0x80000000, v244
  v_xor_b32 v40, 0x80000000, v245
  v_xor_b32 v41, 0x80000000, v245
  v_xor_b32 v42, 0x80000000, v245
  v_xor_b32 v43, 0x80000000, v245
  v_xor_b32 v44, 0x80000000, v246
  v_xor_b32 v45, 0x80000000, v246
  v_xor_b32 v46, 0x80000000, v246
  v_xor_b32 v47, 0x80000000, v246
  v_xor_b32 v48, 0x80000000, v247
  v_xor_b32 v49, 0x80000000, v247
  v_xor_b32 v50, 0x80000000, v247
  v_xor_b32 v51, 0x80000000, v247
M_restart:
  s_mov_b32 s4, 2
  s_mov_b32 s48, s53
  s_mov_b32 s52, 0
  buffer_load_dwordx4 a[0:3], v8, s[40:43], s48 offen offset:0 sc1
  buffer_load_dwordx4 a[4:7], v8, s[40:43], s48 offen offset:1024 sc1
  buffer_load_dwordx4 a[8:11], v8, s[40:43], s48 offen offset:2048 sc1
  buffer_load_dwordx4 a[12:15], v8, s[40:43], s48 offen offset:3072 sc1
  buffer_load_dwordx4 a[16:19], v9, s[40:43], s48 offen offset:0 sc1
  buffer_load_dwordx4 a[20:23], v9, s[40:43], s48 offen offset:1024 sc1
  buffer_load_dwordx4 a[24:27], v9, s[40:43], s48 offen offset:2048 sc1
  buffer_load_dwordx4 a[28:31], v9, s[40:43], s48 offen offset:3072 sc1
  buffer_load_dwordx4 a[32:35], v10, s[40:43], s48 offen offset:0 sc1
  buffer_load_dwordx4 a[36:39], v10, s[40:43], s48 offen offset:1024 sc1
  buffer_load_dwordx4 a[40:43], v10, s[40:43], s48 offen offset:2048 sc1
  buffer_load_dwordx4 a[44:47], v10, s[40:43], s48 offen offset:3072 sc1
  buffer_load_dwordx4 a[48:51], v11, s[40:43], s48 offen offset:0 sc1
  buffer_load_dwordx4 a[52:55], v11, s[40:43], s48 offen offset:1024 sc1
  buffer_load_dwordx4 a[56:59], v11, s[40:43], s48 offen offset:2048 sc1
  buffer_load_dwordx4 a[60:63], v11, s[40:43], s48 offen offset:3072 sc1
  s_add_u32 s48, s48, 0x4000
  buffer_load_dwordx4 a[64:67], v8, s[40:43], s48 offen offset:0 sc1
  buffer_load_dwordx4 a[68:71], v8, s[40:43], s48 offen offset:1024 sc1
  buffer_load_dwordx4 a[72:75], v8, s[40:43], s48 offen offset:2048 sc1
  buffer_load_dwordx4 a[76:79], v8, s[40:43], s48 offen offset:3072 sc1
  buffer_load_dwordx4 a[80:83], v9, s[40:43], s48 offen offset:0 sc1
  buffer_load_dwordx4 a[84:87], v9, s[40:43], s48 offen offset:1024 sc1
  s_waitcnt vmcnt(0)
  v_mfma_f32_16x16x32_bf16 v[12:15], a[0:3], a[128:131], v[36:39]
  v_mfma_f32_16x16x32_bf16 v[12:15], a[4:7], a[132:135], v[12:15]
  v_mfma_f32_16x16x32_bf16 v[12:15], a[8:11], a[136:139], v[12:15]
  v_mfma_f32_16x16x32_bf16 v[12:15], a[12:15], a[140:143], v[12:15]
  v_mfma_f32_16x16x32_bf16 v[16:19], a[16:19], a[128:131], v[36:39]
  v_mfma_f32_16x16x32_bf16 v[16:19], a[20:23], a[132:135], v[16:19]
  v_mfma_f32_16x16x32_bf16 v[16:19], a[24:27], a[136:139], v[16:19]
  v_mfma_f32_16x16x32_bf16 v[16:19], a[28:31], a[140:143], v[16:19]
  s_nop 7
  s_branch M_go
.section .rodata,"a"
.p2align 6
.amdhsa_kernel standalone__kv_cache_quant_pre_rope_vs_post_rope__prompt_kernel
  .amdhsa_next_free_vgpr 512
  .amdhsa_next_free_sgpr 102
  .amdhsa_accum_offset 256
  .amdhsa_group_segment_fixed_size 0
  .amdhsa_kernarg_size 112
  .amdhsa_user_sgpr_count 2
  .amdhsa_user_sgpr_kernarg_segment_ptr 1
  .amdhsa_system_sgpr_workgroup_id_x 1
  .amdhsa_float_denorm_mode_32 3
.end_amdhsa_kernel
```
